```python
import torch

def _softmax(x, axis=-1):
    return torch.softmax(x, dim=axis)
def _gelu(x):
    return torch.nn.functional.gelu(x, approximate="tanh")
def _silu(x):
    return torch.nn.functional.silu(x)
def _sigmoid(x):
    return torch.sigmoid(x)
def _layernorm(x, axis=-1, eps=1e-5):
    m = x.mean(dim=axis, keepdim=True)
    v = x.var(dim=axis, keepdim=True, unbiased=False)
    return (x - m) / torch.sqrt(v + eps)
def _scatter_add(tgt, idx, src, axis=0):
    return tgt.clone().index_add_(axis, idx, src)
def _segment_sum(src, seg, n):
    out = torch.zeros((n,) + src.shape[1:], dtype=src.dtype)
    return out.index_add_(0, seg, src)
def _pad(x, pw):
    flat = tuple(v for pair in reversed(pw) for v in pair)
    return torch.nn.functional.pad(x, flat)

kernel_name = 'parallel_sum__ssm_conv_s5__mixer_channel_mlp__prompt'

def setup_inputs():

    _w = (lambda a: (lambda t: t.to(torch.bfloat16) if t.is_floating_point() else t)(torch.as_tensor(a)))
    def _A_setup():
        B, S, D = 1, 2048, 448
        P = D
        Lambda_re = -0.5 * (lambda _x: torch.exp(torch.as_tensor(_x)))((lambda *s: torch.randn(*s, dtype=torch.bfloat16) * 0.2)(P))
        Lambda_im = (lambda *s: torch.randn(*s, dtype=torch.bfloat16) * 0.8)(P) * 1.0
        B_re = (lambda *s: torch.randn(*s, dtype=torch.bfloat16) * 0.2)(P, D) * (D ** -0.5)
        B_im = (lambda *s: torch.randn(*s, dtype=torch.bfloat16) * 0.2)(P, D) * (D ** -0.5)
        C_re = (lambda *s: torch.randn(*s, dtype=torch.bfloat16) * 0.2)(D, P) * (P ** -0.5)
        C_im = (lambda *s: torch.randn(*s, dtype=torch.bfloat16) * 0.2)(D, P) * (P ** -0.5)
        log_dt = (lambda *s: torch.randn(*s, dtype=torch.bfloat16) * 0.2)(P) * 0.3 - 2.0
        Dskip = (lambda *s: torch.randn(*s, dtype=torch.bfloat16) * 0.05)(D)
        return {
            "x": _w((lambda *s: torch.randn(*s, dtype=torch.bfloat16) * 0.05)(B, S, D)),
            "Lambda_re": _w(Lambda_re),
            "Lambda_im": _w(Lambda_im),
            "B_re": _w(B_re),
            "B_im": _w(B_im),
            "C_re": _w(C_re),
            "C_im": _w(C_im),
            "log_dt": _w(log_dt),
            "Dskip": _w(Dskip),
        }
    _A_in = _A_setup()

    def _B_setup():
        B, S, D, F = 1, 2048, 448, 1792
        return {
            "x": _w((lambda *s: torch.randn(*s, dtype=torch.bfloat16) * 0.05)(B, S, D)),
            "w1": _w((lambda *s: torch.randn(*s, dtype=torch.bfloat16) * 1.6)(D, F) * (D ** -0.5)),
            "b1": _w((lambda *s: torch.randn(*s, dtype=torch.bfloat16) * 0.8)(F)),
            "w2": _w((lambda *s: torch.randn(*s, dtype=torch.bfloat16) * 0.05)(F, D) * (F ** -0.5)),
            "b2": _w((lambda *s: torch.randn(*s, dtype=torch.bfloat16) * 0.05)(D)),
        }
    _B_in = _B_setup()

    return {
        "A_x": _A_in["x"],
        "A_Lambda_re": _A_in["Lambda_re"],
        "A_Lambda_im": _A_in["Lambda_im"],
        "A_B_re": _A_in["B_re"],
        "A_B_im": _A_in["B_im"],
        "A_C_re": _A_in["C_re"],
        "A_C_im": _A_in["C_im"],
        "A_log_dt": _A_in["log_dt"],
        "A_Dskip": _A_in["Dskip"],
        "B_x": _B_in["x"],
        "B_w1": _B_in["w1"],
        "B_b1": _B_in["b1"],
        "B_w2": _B_in["w2"],
        "B_b2": _B_in["b2"],
    }

def reference(A_x, A_Lambda_re, A_Lambda_im, A_B_re, A_B_im, A_C_re, A_C_im, A_log_dt, A_Dskip, B_x, B_w1, B_b1, B_w2, B_b2):
    def _A_ref(x, Lambda_re, Lambda_im, B_re, B_im, C_re, C_im, log_dt, Dskip):
        Bsz, L, H = x.shape
        Lam = Lambda_re + 1j * Lambda_im
        Bmat = B_re + 1j * B_im
        Cmat = C_re + 1j * C_im
        dt = torch.exp(log_dt)
        Lam_bar = torch.exp(dt * Lam)
        B_bar = ((Lam_bar - 1.0) / Lam)[:, None] * Bmat
        Bu = torch.einsum("bld,pd->blp", x + 0j, B_bar)
        h = torch.zeros_like(Bu[:, 0, :])
        hs = []
        for t in range(L):
            h = Lam_bar[None, :] * h + Bu[:, t, :]
            hs.append(h)
        hseq = torch.stack(hs, 1)
        y = 2.0 * torch.einsum("blp,dp->bld", hseq, Cmat).real + x * Dskip[None, None, :]
        return y

    def _B_ref(x, w1, b1, w2, b2):
        y = _layernorm(x, axis=-1)
        h = _gelu(torch.einsum("bsd,df->bsf", y, w1) + b1)
        return torch.einsum("bsf,fd->bsd", h, w2) + b2

    x = A_x
    xn = _layernorm(x, axis=-1)
    return x + _A_ref(xn, A_Lambda_re, A_Lambda_im, A_B_re, A_B_im, A_C_re, A_C_im, A_log_dt, A_Dskip) + _B_ref(xn, B_w1, B_b1, B_w2, B_b2)
```

```asm
; @launch grid=(256,1,1) block=(512,1,1) lds=163840
.amdgcn_target "amdgcn-amd-amdhsa--gfx950"
.text
.globl parallel_sum__ssm_conv_s5__mixer_channel_mlp__prompt_kernel
.p2align 8
.type parallel_sum__ssm_conv_s5__mixer_channel_mlp__prompt_kernel,@function
parallel_sum__ssm_conv_s5__mixer_channel_mlp__prompt_kernel:
    s_cmp_ge_u32 s2, 256
    s_cbranch_scc1 K1_END
    s_and_b32 s42, s2, 7
    s_lshr_b32 s43, s2, 3
    s_and_b32 s92, s43, 15
    s_lshr_b32 s39, s42, 2
    s_mul_i32 s38, s92, 2
    s_add_u32 s39, s39, s38
    s_and_b32 s38, s42, 3
    s_mul_i32 s38, s38, 2
    s_lshr_b32 s43, s43, 4
    s_add_u32 s38, s38, s43
    s_cmp_ge_u32 s38, 7
    s_cbranch_scc1 K1_COLL
    s_nop 0
    s_load_dwordx16 s[4:19], s[0:1], 0
    s_load_dwordx16 s[20:35], s[0:1], 64
    s_load_dwordx2 s[36:37], s[0:1], 128
    v_lshrrev_b32 v2, 6, v0
    v_and_b32 v1, 63, v0
    s_getpc_b64 s[94:95]
K1_PC:
    s_sub_u32 s94, s94, K1_PC-parallel_sum__ssm_conv_s5__mixer_channel_mlp__prompt_kernel
    s_subb_u32 s95, s95, 0
    s_lshr_b32 s96, s2, 3
    s_mul_i32 s96, s96, 768
    v_lshlrev_b32 v3, 7, v0
    v_add_u32_e64 v3, s96, v3
    v_cmp_gt_u32 s[84:85], 6, v0
    v_cmp_gt_u32 vcc, K1_END-parallel_sum__ssm_conv_s5__mixer_channel_mlp__prompt_kernel, v3
    s_nop 2
    s_and_b64 vcc, vcc, s[84:85]
    s_and_saveexec_b64 s[96:97], vcc
    s_cbranch_execz K1_NOCT
    global_load_dword v251, v3, s[94:95]
K1_NOCT:
    s_mov_b64 exec, s[96:97]
    v_readfirstlane_b32 s40, v2
    s_nop 2
    s_xor_b32 s40, s40, 4
    v_lshrrev_b32 v3, 3, v1
    v_and_b32 v4, 7, v1
    v_mul_u32_u24 v5, 896, v3
    v_lshl_add_u32 v10, v4, 4, v5
    v_and_b32 v2, 15, v1
    s_lshl_b32 s42, s39, 3
    s_add_u32 s42, s42, s40
    s_mul_i32 s77, s42, 7168
    s_and_b32 s42, s40, 3
    s_lshl_b32 s42, s42, 4
    s_lshl_b32 s43, s38, 6
    s_add_u32 s88, s42, s43
    v_add_u32 v2, s88, v2
    v_lshlrev_b32 v2, 1, v2
    s_waitcnt lgkmcnt(0)
    s_mov_b32 s44, s4
    s_mov_b32 s45, s5
    s_mov_b32 s46, 1835008
    s_mov_b32 s47, 0x20000
    global_load_ushort v104, v2, s[6:7]
    global_load_ushort v105, v2, s[8:9]
    global_load_ushort v106, v2, s[18:19]
    buffer_load_dwordx4 v[32:35], v10, s[44:47], s77 offen offset:0
    buffer_load_dwordx4 v[36:39], v10, s[44:47], s77 offen offset:128
    buffer_load_dwordx4 v[40:43], v10, s[44:47], s77 offen offset:256
    buffer_load_dwordx4 v[44:47], v10, s[44:47], s77 offen offset:384
    buffer_load_dwordx4 v[48:51], v10, s[44:47], s77 offen offset:512
    buffer_load_dwordx4 v[52:55], v10, s[44:47], s77 offen offset:640
    buffer_load_dwordx4 v[56:59], v10, s[44:47], s77 offen offset:768
    s_mov_b32 s52, s28
    s_mov_b32 s53, s29
    s_mov_b32 s54, 1605632
    s_mov_b32 s55, 0x20000
    s_mov_b32 s56, s14
    s_mov_b32 s57, s15
    s_mov_b32 s58, 401408
    s_mov_b32 s59, 0x20000
    s_mov_b32 s60, s16
    s_mov_b32 s61, s17
    s_mov_b32 s62, 401408
    s_mov_b32 s63, 0x20000
    s_mov_b32 s68, s36
    s_mov_b32 s69, s37
    s_mov_b32 s70, 16777216
    s_mov_b32 s71, 0x20000
    s_mov_b32 s72, s34
    s_mov_b32 s73, s35
    s_mov_b32 s74, 256
    s_mov_b32 s75, 0x20000
    v_lshrrev_b32 v6, 4, v1
    v_and_b32 v7, 1, v6
    v_lshlrev_b32 v7, 2, v7
    v_xor_b32 v7, v4, v7
    v_xor_b32_e64 v8, v4, v6
    v_lshl_add_u32 v31, v8, 4, v5
    v_xor_b32_e64 v11, 64, v31
    v_add_u32 v11, 6144, v11
    v_lshl_add_u32 v29, v7, 4, v5
    v_add_u32 v30, 6144, v29
    s_and_b32 s42, s40, 3
    s_mul_i32 s42, s42, 28
    v_add_u32 v6, s42, v1
    v_lshrrev_b32 v9, 2, v6
    v_mul_u32_u24 v9, 16, v9
    v_add_u32 v9, s92, v9
    v_mul_u32_u24 v9, 3584, v9
    v_and_b32_e64 v6, 3, v6
    v_lshl_add_u32 v248, v6, 7, v9
    s_lshl_b32 s42, s38, 9
    v_add_u32 v248, s42, v248
    v_lshlrev_b32 v249, 7, v1
    v_lshrrev_b32 v6, 4, v1
    s_mul_i32 s80, s38, 229376
    s_lshl_b32 s42, s40, 7
    s_add_u32 s80, s80, s42
    s_mul_i32 s79, s40, 57344
    s_lshl_b32 s42, s38, 7
    s_add_u32 s79, s79, s42
    s_lshl_b32 s42, s40, 3
    v_add_u32 v62, s42, v3
    v_bfe_u32 v63, v62, 1, 3
    s_lshr_b32 s42, s40, 1
    s_and_b32 s43, s42, 1
    s_mul_i32 s43, s43, 3
    s_lshr_b32 s42, s42, 1
    s_xor_b32 s42, s42, s43
    s_lshl_b32 s42, s42, 1
    v_xor_b32 v63, s42, v63
    v_xor_b32 v63, v63, v4
    v_mul_u32_u24 v61, 896, v62
    v_lshl_add_u32 v10, v63, 4, v61
    v_lshlrev_b32 v62, 2, v62
    v_mov_b32 v60, 0
    v_mov_b32 v63, 158208
    ds_write_b32 v63, v60 offset:0
    ds_write_b32 v63, v60 offset:4
    ds_write_b32 v63, v60 offset:8
    ds_write_b32 v63, v60 offset:12
    ds_write_b32 v63, v60 offset:16
    ds_write_b32 v63, v60 offset:20
    ds_write_b32 v63, v60 offset:24
    ds_write_b32 v63, v60 offset:28
    ds_write_b32 v63, v60 offset:32
    ds_write_b32 v63, v60 offset:36
    ds_write_b32 v63, v60 offset:40
    ds_write_b32 v63, v60 offset:44
    s_cmp_ge_u32 s40, 4
    s_cbranch_scc1 K1_G1_PRE
    s_mov_b32 s48, s24
    s_mov_b32 s49, s25
    s_mov_b32 s50, 1605632
    s_mov_b32 s51, 0x20000
    s_mov_b32 s64, s24
    s_mov_b32 s65, s25
    s_mov_b32 s66, 1605632
    s_mov_b32 s67, 0x20000
    s_mul_i32 s41, s40, 12288
    s_add_u32 s41, s41, 106496
    s_mov_b32 s78, s41
    s_lshl_b32 s76, s38, 9
    s_lshl_b32 s42, s40, 7
    s_add_u32 s76, s76, s42
    s_mov_b32 s89, 57344
    s_mov_b32 s90, 57344
    v_mul_u32_u24 v27, 3584, v3
    v_lshl_add_u32 v27, v7, 4, v27
    v_add_u32 v28, 27648, v27
    s_mov_b32 s91, s76
    v_mov_b32 v247, 0
    v_mov_b32 v250, 0
    v_lshrrev_b32 v2, 5, v1
    v_bfe_u32 v3, v1, 2, 2
    v_and_b32_e64 v4, 3, v1
    v_bfe_u32 v5, v1, 4, 1
    v_lshlrev_b32 v6, 1, v5
    v_lshrrev_b32 v7, 1, v4
    v_or_b32 v6, v6, v7
    v_lshrrev_b32 v7, 1, v3
    v_lshlrev_b32 v7, 2, v7
    v_xor_b32 v6, v6, v7
    v_lshlrev_b32 v6, 4, v6
    v_and_b32 v7, 1, v4
    v_lshl_add_u32 v6, v7, 3, v6
    v_lshl_add_u32 v7, v2, 3, v3
    v_lshl_add_u32 v8, v7, 7, v6
    v_lshl_add_u32 v7, v2, 2, v3
    v_lshl_add_u32 v9, v7, 7, v6
    v_add_u32 v18, s78, v9
    v_xor_b32 v19, 64, v18
    v_add_u32 v21, 65536, v8
    v_xor_b32 v22, 64, v21
    v_lshlrev_b32 v20, 4, v1
    v_add_u32 v20, 57344, v20
    v_and_b32 v3, 31, v1
    v_lshrrev_b32 v2, 5, v1
    v_bfe_u32 v4, v3, 1, 3
    v_xor_b32 v4, v4, v2
    v_lshlrev_b32 v4, 4, v4
    v_lshl_add_u32 v4, v3, 7, v4
    v_add_u32 v23, s78, v4
    v_xor_b32 v24, 32, v23
    v_xor_b32_e64 v25, 64, v23
    v_xor_b32 v26, 96, v23
    v_add_u32 v12, s41, v8
    v_xor_b32 v13, 64, v12
    v_lshrrev_b32 v2, 5, v1
    v_and_b32 v3, 31, v1
    v_bfe_u32 v4, v3, 1, 3
    v_lshrrev_b32 v5, 4, v3
    v_mul_u32_u24 v5, 6, v5
    v_xor_b32 v4, v4, v5
    v_xor_b32 v4, v4, v2
    v_mul_u32_u24 v5, 896, v3
    v_xor_b32_e64 v6, 0, v4
    v_lshl_add_u32 v14, v6, 4, v5
    v_xor_b32_e64 v6, 2, v4
    v_lshl_add_u32 v15, v6, 4, v5
    v_xor_b32_e64 v6, 4, v4
    v_lshl_add_u32 v16, v6, 4, v5
    v_xor_b32_e64 v6, 6, v4
    v_lshl_add_u32 v17, v6, 4, v5
    s_barrier
    s_waitcnt vmcnt(0)
    v_lshrrev_b32 v2, 5, v1
    v_lshlrev_b32 v2, 3, v2
    v_add_u32_e64 v2, s76, v2
    global_load_dwordx2 v[224:225], v2, s[26:27] offset:0
    global_load_dwordx2 v[226:227], v2, s[26:27] offset:16
    global_load_dwordx2 v[228:229], v2, s[26:27] offset:32
    global_load_dwordx2 v[230:231], v2, s[26:27] offset:48
    global_load_dwordx2 v[232:233], v2, s[26:27] offset:64
    global_load_dwordx2 v[234:235], v2, s[26:27] offset:80
    global_load_dwordx2 v[236:237], v2, s[26:27] offset:96
    global_load_dwordx2 v[238:239], v2, s[26:27] offset:112
    v_mov_b32 v2, 0
    v_mov_b32 v3, 0
    v_mov_b32 v4, 0
    v_mov_b32 v5, 0
    v_mov_b32 v60, 0x3f803f80
    v_dot2c_f32_bf16 v2, v60, v32
    v_dot2c_f32_bf16 v4, v32, v32
    v_dot2c_f32_bf16 v3, v60, v33
    v_dot2c_f32_bf16 v5, v33, v33
    v_dot2c_f32_bf16 v2, v60, v34
    v_dot2c_f32_bf16 v4, v34, v34
    v_dot2c_f32_bf16 v3, v60, v35
    v_dot2c_f32_bf16 v5, v35, v35
    v_dot2c_f32_bf16 v2, v60, v36
    v_dot2c_f32_bf16 v4, v36, v36
    v_dot2c_f32_bf16 v3, v60, v37
    v_dot2c_f32_bf16 v5, v37, v37
    v_dot2c_f32_bf16 v2, v60, v38
    v_dot2c_f32_bf16 v4, v38, v38
    v_dot2c_f32_bf16 v3, v60, v39
    v_dot2c_f32_bf16 v5, v39, v39
    v_dot2c_f32_bf16 v2, v60, v40
    v_dot2c_f32_bf16 v4, v40, v40
    v_dot2c_f32_bf16 v3, v60, v41
    v_dot2c_f32_bf16 v5, v41, v41
    v_dot2c_f32_bf16 v2, v60, v42
    v_dot2c_f32_bf16 v4, v42, v42
    v_dot2c_f32_bf16 v3, v60, v43
    v_dot2c_f32_bf16 v5, v43, v43
    v_dot2c_f32_bf16 v2, v60, v44
    v_dot2c_f32_bf16 v4, v44, v44
    v_dot2c_f32_bf16 v3, v60, v45
    v_dot2c_f32_bf16 v5, v45, v45
    v_dot2c_f32_bf16 v2, v60, v46
    v_dot2c_f32_bf16 v4, v46, v46
    v_dot2c_f32_bf16 v3, v60, v47
    v_dot2c_f32_bf16 v5, v47, v47
    v_dot2c_f32_bf16 v2, v60, v48
    v_dot2c_f32_bf16 v4, v48, v48
    v_dot2c_f32_bf16 v3, v60, v49
    v_dot2c_f32_bf16 v5, v49, v49
    v_dot2c_f32_bf16 v2, v60, v50
    v_dot2c_f32_bf16 v4, v50, v50
    v_dot2c_f32_bf16 v3, v60, v51
    v_dot2c_f32_bf16 v5, v51, v51
    v_dot2c_f32_bf16 v2, v60, v52
    v_dot2c_f32_bf16 v4, v52, v52
    v_dot2c_f32_bf16 v3, v60, v53
    v_dot2c_f32_bf16 v5, v53, v53
    v_dot2c_f32_bf16 v2, v60, v54
    v_dot2c_f32_bf16 v4, v54, v54
    v_dot2c_f32_bf16 v3, v60, v55
    v_dot2c_f32_bf16 v5, v55, v55
    v_dot2c_f32_bf16 v2, v60, v56
    v_dot2c_f32_bf16 v4, v56, v56
    v_dot2c_f32_bf16 v3, v60, v57
    v_dot2c_f32_bf16 v5, v57, v57
    v_dot2c_f32_bf16 v2, v60, v58
    v_dot2c_f32_bf16 v4, v58, v58
    v_dot2c_f32_bf16 v3, v60, v59
    v_dot2c_f32_bf16 v5, v59, v59
    s_nop 1
    v_add_f32 v2, v2, v3
    v_lshlrev_b32 v128, 16, v32
    v_add_f32 v4, v4, v5
    v_and_b32 v129, 0xffff0000, v32
    v_add_f32_dpp v2, v2, v2 quad_perm:[1,0,3,2] row_mask:0xf bank_mask:0xf
    v_lshlrev_b32_e64 v130, 16, v33
    v_add_f32_dpp v4, v4, v4 quad_perm:[1,0,3,2] row_mask:0xf bank_mask:0xf
    v_and_b32 v131, 0xffff0000, v33
    v_add_f32_dpp v2, v2, v2 quad_perm:[2,3,0,1] row_mask:0xf bank_mask:0xf
    v_lshlrev_b32_e64 v132, 16, v34
    v_add_f32_dpp v4, v4, v4 quad_perm:[2,3,0,1] row_mask:0xf bank_mask:0xf
    v_and_b32 v133, 0xffff0000, v34
    v_add_f32_dpp v2, v2, v2 row_half_mirror row_mask:0xf bank_mask:0xf
    v_lshlrev_b32_e64 v134, 16, v35
    v_add_f32_dpp v4, v4, v4 row_half_mirror row_mask:0xf bank_mask:0xf
    v_and_b32 v135, 0xffff0000, v35
    v_mul_f32 v5, 0x3b124925, v2
    v_lshlrev_b32_e64 v136, 16, v36
    v_mul_f32 v4, 0x3b124925, v4
    v_and_b32 v137, 0xffff0000, v36
    v_fma_f32 v4, -v5, v5, v4
    v_lshlrev_b32 v138, 16, v37
    v_max_f32 v4, 0, v4
    v_and_b32 v139, 0xffff0000, v37
    v_add_f32 v6, 0x3727c5ac, v4
    v_lshlrev_b32 v140, 16, v38
    v_rsq_f32 v6, v6
    v_and_b32 v141, 0xffff0000, v38
    v_mul_f32 v7, v6, v6
    v_lshlrev_b32 v142, 16, v39
    v_mul_f32_e64 v7, v7, v4
    v_and_b32 v143, 0xffff0000, v39
    v_add_f32 v7, 0x3727c5ac, v7
    v_lshlrev_b32 v144, 16, v40
    v_rsq_f32 v9, v7
    v_and_b32 v145, 0xffff0000, v40
    v_mul_f32 v3, v6, v9
    v_lshlrev_b32 v146, 16, v41
    v_mul_f32_e64 v8, v7, v9
    v_and_b32 v147, 0xffff0000, v41
    v_mul_f32 v2, v5, v3
    v_lshlrev_b32 v148, 16, v42
    v_sub_f32_e64 v2, 0, v2
    v_and_b32 v149, 0xffff0000, v42
    v_lshlrev_b32_e64 v150, 16, v43
    v_and_b32 v151, 0xffff0000, v43
    v_lshlrev_b32_e64 v152, 16, v44
    v_and_b32 v153, 0xffff0000, v44
    v_lshlrev_b32_e64 v154, 16, v45
    v_and_b32 v155, 0xffff0000, v45
    v_lshlrev_b32_e64 v156, 16, v46
    v_and_b32 v157, 0xffff0000, v46
    v_lshlrev_b32_e64 v158, 16, v47
    v_and_b32 v159, 0xffff0000, v47
    v_lshlrev_b32_e64 v160, 16, v48
    v_and_b32 v161, 0xffff0000, v48
    v_lshlrev_b32_e64 v162, 16, v49
    v_and_b32 v163, 0xffff0000, v49
    v_lshlrev_b32_e64 v164, 16, v50
    v_and_b32 v165, 0xffff0000, v50
    v_lshlrev_b32_e64 v166, 16, v51
    v_and_b32 v167, 0xffff0000, v51
    v_lshlrev_b32_e64 v168, 16, v52
    v_and_b32 v169, 0xffff0000, v52
    v_lshlrev_b32_e64 v170, 16, v53
    v_and_b32 v171, 0xffff0000, v53
    v_lshlrev_b32_e64 v172, 16, v54
    v_and_b32 v173, 0xffff0000, v54
    v_lshlrev_b32_e64 v174, 16, v55
    v_and_b32 v175, 0xffff0000, v55
    v_lshlrev_b32_e64 v176, 16, v56
    v_and_b32 v177, 0xffff0000, v56
    v_lshlrev_b32_e64 v178, 16, v57
    v_and_b32 v179, 0xffff0000, v57
    v_lshlrev_b32_e64 v180, 16, v58
    v_and_b32 v181, 0xffff0000, v58
    v_lshlrev_b32_e64 v182, 16, v59
    v_and_b32 v183, 0xffff0000, v59
    v_mov_b32 v60, v3
    v_mov_b32 v61, v3
    v_mov_b32 v4, v2
    v_mov_b32 v63, v5
    v_mov_b32_e64 v5, v2
    v_pk_fma_f32 v[128:129], v[128:129], v[60:61], v[4:5]
    v_pk_fma_f32 v[130:131], v[130:131], v[60:61], v[4:5]
    v_pk_fma_f32 v[132:133], v[132:133], v[60:61], v[4:5]
    v_pk_fma_f32 v[134:135], v[134:135], v[60:61], v[4:5]
    v_cvt_pk_bf16_f32 v32, v128, v129
    v_cvt_pk_bf16_f32 v33, v130, v131
    v_cvt_pk_bf16_f32 v34, v132, v133
    v_cvt_pk_bf16_f32 v35, v134, v135
    ds_write_b128 v10, v[32:35] offset:0
    v_pk_fma_f32 v[136:137], v[136:137], v[60:61], v[4:5]
    v_pk_fma_f32 v[138:139], v[138:139], v[60:61], v[4:5]
    v_pk_fma_f32 v[140:141], v[140:141], v[60:61], v[4:5]
    v_pk_fma_f32 v[142:143], v[142:143], v[60:61], v[4:5]
    v_cvt_pk_bf16_f32 v36, v136, v137
    v_cvt_pk_bf16_f32 v37, v138, v139
    v_cvt_pk_bf16_f32 v38, v140, v141
    v_cvt_pk_bf16_f32 v39, v142, v143
    ds_write_b128 v10, v[36:39] offset:128
    v_pk_fma_f32 v[144:145], v[144:145], v[60:61], v[4:5]
    v_pk_fma_f32 v[146:147], v[146:147], v[60:61], v[4:5]
    v_pk_fma_f32 v[148:149], v[148:149], v[60:61], v[4:5]
    v_pk_fma_f32 v[150:151], v[150:151], v[60:61], v[4:5]
    v_cvt_pk_bf16_f32 v40, v144, v145
    v_cvt_pk_bf16_f32 v41, v146, v147
    v_cvt_pk_bf16_f32 v42, v148, v149
    v_cvt_pk_bf16_f32 v43, v150, v151
    ds_write_b128 v10, v[40:43] offset:256
    v_pk_fma_f32 v[152:153], v[152:153], v[60:61], v[4:5]
    v_pk_fma_f32 v[154:155], v[154:155], v[60:61], v[4:5]
    v_pk_fma_f32 v[156:157], v[156:157], v[60:61], v[4:5]
    v_pk_fma_f32 v[158:159], v[158:159], v[60:61], v[4:5]
    v_cvt_pk_bf16_f32 v44, v152, v153
    v_cvt_pk_bf16_f32 v45, v154, v155
    v_cvt_pk_bf16_f32 v46, v156, v157
    v_cvt_pk_bf16_f32 v47, v158, v159
    ds_write_b128 v10, v[44:47] offset:384
    v_pk_fma_f32 v[160:161], v[160:161], v[60:61], v[4:5]
    v_pk_fma_f32 v[162:163], v[162:163], v[60:61], v[4:5]
    v_pk_fma_f32 v[164:165], v[164:165], v[60:61], v[4:5]
    v_pk_fma_f32 v[166:167], v[166:167], v[60:61], v[4:5]
    v_cvt_pk_bf16_f32 v48, v160, v161
    v_cvt_pk_bf16_f32 v49, v162, v163
    v_cvt_pk_bf16_f32 v50, v164, v165
    v_cvt_pk_bf16_f32 v51, v166, v167
    ds_write_b128 v10, v[48:51] offset:512
    v_pk_fma_f32 v[168:169], v[168:169], v[60:61], v[4:5]
    v_pk_fma_f32 v[170:171], v[170:171], v[60:61], v[4:5]
    v_pk_fma_f32 v[172:173], v[172:173], v[60:61], v[4:5]
    v_pk_fma_f32 v[174:175], v[174:175], v[60:61], v[4:5]
    v_cvt_pk_bf16_f32 v52, v168, v169
    v_cvt_pk_bf16_f32 v53, v170, v171
    v_cvt_pk_bf16_f32 v54, v172, v173
    v_cvt_pk_bf16_f32 v55, v174, v175
    ds_write_b128 v10, v[52:55] offset:640
    v_pk_fma_f32 v[176:177], v[176:177], v[60:61], v[4:5]
    v_pk_fma_f32 v[178:179], v[178:179], v[60:61], v[4:5]
    v_pk_fma_f32 v[180:181], v[180:181], v[60:61], v[4:5]
    v_pk_fma_f32 v[182:183], v[182:183], v[60:61], v[4:5]
    v_cvt_pk_bf16_f32 v56, v176, v177
    v_cvt_pk_bf16_f32 v57, v178, v179
    v_cvt_pk_bf16_f32 v58, v180, v181
    v_cvt_pk_bf16_f32 v59, v182, v183
    ds_write_b128 v10, v[56:59] offset:768
    v_and_b32 v2, 7, v1
    v_cmp_eq_u32 vcc, 0, v2
    s_nop 2
    s_and_saveexec_b64 s[82:83], vcc
    v_add_u32 v2, 155648, v62
    ds_write_b32 v2, v8
    ds_write_b32 v2, v63 offset:256
    ds_write_b32 v2, v6 offset:2816
    s_mov_b64 exec, s[82:83]
    s_waitcnt lgkmcnt(0)
    s_add_u32 s6, s41, 0
    s_add_u32 s12, s78, 0
    s_add_u32 s7, s41, 2048
    s_add_u32 s13, s78, 2048
    s_add_u32 s8, s41, 4096
    s_add_u32 s14, s78, 4096
    s_add_u32 s9, s41, 6144
    s_add_u32 s15, s78, 6144
    s_add_u32 s10, s41, 8192
    s_add_u32 s16, s78, 8192
    s_add_u32 s11, s41, 10240
    s_add_u32 s17, s78, 10240
    s_mov_b32 s91, s76
    s_barrier
    s_add_u32 m0, s41, 0
    s_nop 0
    buffer_load_dwordx4 v27, s[48:51], s91 offen lds
    buffer_load_dwordx4 v28, s[48:51], s91 offen offset:1024 lds
    s_add_u32 s91, s91, s89
    s_add_u32 m0, s41, 2048
    s_nop 0
    buffer_load_dwordx4 v27, s[64:67], s91 offen lds
    buffer_load_dwordx4 v28, s[64:67], s91 offen offset:1024 lds
    s_add_u32 s91, s91, s90
    s_waitcnt vmcnt(4)
    v_lshlrev_b32_e64 v128, 16, v224
    v_and_b32 v129, 0xffff0000, v224
    v_lshlrev_b32_e64 v130, 16, v225
    v_and_b32 v131, 0xffff0000, v225
    v_lshlrev_b32_e64 v132, 16, v226
    v_and_b32 v133, 0xffff0000, v226
    v_lshlrev_b32_e64 v134, 16, v227
    v_and_b32 v135, 0xffff0000, v227
    v_lshlrev_b32_e64 v136, 16, v228
    v_and_b32 v137, 0xffff0000, v228
    v_lshlrev_b32_e64 v138, 16, v229
    v_and_b32 v139, 0xffff0000, v229
    v_lshlrev_b32_e64 v140, 16, v230
    v_and_b32 v141, 0xffff0000, v230
    v_lshlrev_b32_e64 v142, 16, v231
    v_and_b32 v143, 0xffff0000, v231
    v_lshlrev_b32_e64 v144, 16, v232
    v_and_b32 v145, 0xffff0000, v232
    v_lshlrev_b32_e64 v146, 16, v233
    v_and_b32 v147, 0xffff0000, v233
    v_lshlrev_b32_e64 v148, 16, v234
    v_and_b32 v149, 0xffff0000, v234
    v_lshlrev_b32_e64 v150, 16, v235
    v_and_b32 v151, 0xffff0000, v235
    v_lshlrev_b32_e64 v152, 16, v236
    v_and_b32 v153, 0xffff0000, v236
    v_lshlrev_b32_e64 v154, 16, v237
    v_and_b32 v155, 0xffff0000, v237
    v_lshlrev_b32_e64 v156, 16, v238
    v_and_b32 v157, 0xffff0000, v238
    v_lshlrev_b32_e64 v158, 16, v239
    v_and_b32 v159, 0xffff0000, v239
    s_setprio 1
    v_mov_b32 v2, 158228
K1_SPIN1:
    ds_read_b32 v3, v2
    s_waitcnt lgkmcnt(0)
    v_readfirstlane_b32 s42, v3
    s_nop 2
    s_cmp_ge_u32 s42, 4
    s_cbranch_scc0 K1_SPIN1_S
    s_add_u32 m0, s41, 4096
    s_add_u32 s42, s76, 114688
    buffer_load_dwordx4 v27, s[48:51], s42 offen lds
    buffer_load_dwordx4 v28, s[48:51], s42 offen offset:1024 lds
    s_add_u32 m0, s41, 6144
    s_add_u32 s42, s76, 172032
    buffer_load_dwordx4 v27, s[48:51], s42 offen lds
    buffer_load_dwordx4 v28, s[48:51], s42 offen offset:1024 lds
    s_add_u32 m0, s41, 8192
    s_add_u32 s42, s76, 229376
    buffer_load_dwordx4 v27, s[48:51], s42 offen lds
    buffer_load_dwordx4 v28, s[48:51], s42 offen offset:1024 lds
    s_add_u32 m0, s41, 10240
    s_add_u32 s42, s76, 286720
    buffer_load_dwordx4 v27, s[48:51], s42 offen lds
    buffer_load_dwordx4 v28, s[48:51], s42 offen offset:1024 lds
    s_waitcnt vmcnt(10)
    s_nop 0
    ds_read_b64_tr_b16 v[192:193], v12 offset:0
    ds_read_b64_tr_b16 v[194:195], v12 offset:512
    ds_read_b64_tr_b16 v[196:197], v13 offset:0
    ds_read_b64_tr_b16 v[198:199], v13 offset:512
    ds_read_b128 v[200:203], v14 offset:0
    ds_read_b128 v[204:207], v15 offset:28672
    s_waitcnt vmcnt(8)
    s_nop 0
    ds_read_b64_tr_b16 v[208:209], v12 offset:2048
    ds_read_b64_tr_b16 v[210:211], v12 offset:2560
    ds_read_b64_tr_b16 v[212:213], v13 offset:2048
    ds_read_b64_tr_b16 v[214:215], v13 offset:2560
    ds_read_b128 v[216:219], v15 offset:0
    ds_read_b128 v[220:223], v14 offset:28672
    s_waitcnt lgkmcnt(6)
    s_add_u32 m0, s41, 0
    s_add_u32 s42, s76, 344064
    buffer_load_dwordx4 v27, s[48:51], s42 offen lds
    buffer_load_dwordx4 v28, s[48:51], s42 offen offset:1024 lds
    v_mfma_f32_32x32x16_bf16 v[64:79], v[192:195], v[200:203], v[128:143]
    s_waitcnt vmcnt(8) lgkmcnt(0)
    s_mov_b32 m0, s7
    ds_read_b64_tr_b16 v[224:225], v12 offset:4096
    ds_read_b64_tr_b16 v[226:227], v12 offset:4608
    ds_read_b64_tr_b16 v[228:229], v13 offset:4096
    v_mfma_f32_32x32x16_bf16 v[80:95], v[192:195], v[204:207], v[128:143]
    ds_read_b64_tr_b16 v[230:231], v13 offset:4608
    ds_read_b128 v[232:235], v16 offset:0
    ds_read_b128 v[236:239], v17 offset:28672
    s_add_u32 s42, s76, 401408
    v_mfma_f32_32x32x16_bf16 v[96:111], v[196:199], v[200:203], v[144:159]
    buffer_load_dwordx4 v27, s[48:51], s42 offen lds
    v_mfma_f32_32x32x16_bf16 v[112:127], v[196:199], v[204:207], v[144:159]
    buffer_load_dwordx4 v28, s[48:51], s42 offen offset:1024 lds
    v_mfma_f32_32x32x16_bf16 v[64:79], v[208:211], v[216:219], v[64:79]
    s_waitcnt vmcnt(8) lgkmcnt(0)
    s_mov_b32 m0, s8
    ds_read_b64_tr_b16 v[192:193], v12 offset:6144
    ds_read_b64_tr_b16 v[194:195], v12 offset:6656
    ds_read_b64_tr_b16 v[196:197], v13 offset:6144
    v_mfma_f32_32x32x16_bf16 v[80:95], v[208:211], v[220:223], v[80:95]
    ds_read_b64_tr_b16 v[198:199], v13 offset:6656
    ds_read_b128 v[200:203], v17 offset:0
    ds_read_b128 v[204:207], v16 offset:28672
    s_add_u32 s42, s76, 458752
    v_mfma_f32_32x32x16_bf16 v[96:111], v[212:215], v[216:219], v[96:111]
    buffer_load_dwordx4 v27, s[48:51], s42 offen lds
    v_mfma_f32_32x32x16_bf16 v[112:127], v[212:215], v[220:223], v[112:127]
    buffer_load_dwordx4 v28, s[48:51], s42 offen offset:1024 lds
    v_mfma_f32_32x32x16_bf16 v[64:79], v[224:227], v[232:235], v[64:79]
    s_waitcnt vmcnt(8) lgkmcnt(0)
    s_mov_b32 m0, s9
    ds_read_b64_tr_b16 v[208:209], v12 offset:8192
    ds_read_b64_tr_b16 v[210:211], v12 offset:8704
    ds_read_b64_tr_b16 v[212:213], v13 offset:8192
    v_mfma_f32_32x32x16_bf16 v[80:95], v[224:227], v[236:239], v[80:95]
    ds_read_b64_tr_b16 v[214:215], v13 offset:8704
    ds_read_b128 v[216:219], v14 offset:128
    ds_read_b128 v[220:223], v15 offset:28800
    s_add_u32 s42, s76, 516096
    v_mfma_f32_32x32x16_bf16 v[96:111], v[228:231], v[232:235], v[96:111]
    buffer_load_dwordx4 v27, s[48:51], s42 offen lds
    v_mfma_f32_32x32x16_bf16 v[112:127], v[228:231], v[236:239], v[112:127]
    buffer_load_dwordx4 v28, s[48:51], s42 offen offset:1024 lds
    v_mfma_f32_32x32x16_bf16 v[64:79], v[192:195], v[200:203], v[64:79]
    s_waitcnt vmcnt(8) lgkmcnt(0)
    s_mov_b32 m0, s10
    ds_read_b64_tr_b16 v[224:225], v12 offset:10240
    ds_read_b64_tr_b16 v[226:227], v12 offset:10752
    ds_read_b64_tr_b16 v[228:229], v13 offset:10240
    v_mfma_f32_32x32x16_bf16 v[80:95], v[192:195], v[204:207], v[80:95]
    ds_read_b64_tr_b16 v[230:231], v13 offset:10752
    ds_read_b128 v[232:235], v15 offset:128
    ds_read_b128 v[236:239], v14 offset:28800
    s_add_u32 s42, s76, 573440
    v_mfma_f32_32x32x16_bf16 v[96:111], v[196:199], v[200:203], v[96:111]
    buffer_load_dwordx4 v27, s[48:51], s42 offen lds
    v_mfma_f32_32x32x16_bf16 v[112:127], v[196:199], v[204:207], v[112:127]
    buffer_load_dwordx4 v28, s[48:51], s42 offen offset:1024 lds
    v_mfma_f32_32x32x16_bf16 v[64:79], v[208:211], v[216:219], v[64:79]
    s_waitcnt vmcnt(8) lgkmcnt(0)
    s_mov_b32 m0, s11
    ds_read_b64_tr_b16 v[192:193], v12 offset:0
    ds_read_b64_tr_b16 v[194:195], v12 offset:512
    ds_read_b64_tr_b16 v[196:197], v13 offset:0
    v_mfma_f32_32x32x16_bf16 v[80:95], v[208:211], v[220:223], v[80:95]
    ds_read_b64_tr_b16 v[198:199], v13 offset:512
    ds_read_b128 v[200:203], v16 offset:128
    ds_read_b128 v[204:207], v17 offset:28800
    s_add_u32 s42, s76, 630784
    v_mfma_f32_32x32x16_bf16 v[96:111], v[212:215], v[216:219], v[96:111]
    buffer_load_dwordx4 v27, s[48:51], s42 offen lds
    v_mfma_f32_32x32x16_bf16 v[112:127], v[212:215], v[220:223], v[112:127]
    buffer_load_dwordx4 v28, s[48:51], s42 offen offset:1024 lds
    v_mfma_f32_32x32x16_bf16 v[64:79], v[224:227], v[232:235], v[64:79]
    s_waitcnt vmcnt(8) lgkmcnt(0)
    s_mov_b32 m0, s6
    ds_read_b64_tr_b16 v[208:209], v12 offset:2048
    ds_read_b64_tr_b16 v[210:211], v12 offset:2560
    ds_read_b64_tr_b16 v[212:213], v13 offset:2048
    v_mfma_f32_32x32x16_bf16 v[80:95], v[224:227], v[236:239], v[80:95]
    ds_read_b64_tr_b16 v[214:215], v13 offset:2560
    ds_read_b128 v[216:219], v17 offset:128
    ds_read_b128 v[220:223], v16 offset:28800
    s_add_u32 s42, s76, 688128
    v_mfma_f32_32x32x16_bf16 v[96:111], v[228:231], v[232:235], v[96:111]
    buffer_load_dwordx4 v27, s[48:51], s42 offen lds
    v_mfma_f32_32x32x16_bf16 v[112:127], v[228:231], v[236:239], v[112:127]
    buffer_load_dwordx4 v28, s[48:51], s42 offen offset:1024 lds
    v_mfma_f32_32x32x16_bf16 v[64:79], v[192:195], v[200:203], v[64:79]
    s_waitcnt vmcnt(8) lgkmcnt(0)
    s_mov_b32 m0, s7
    ds_read_b64_tr_b16 v[224:225], v12 offset:4096
    ds_read_b64_tr_b16 v[226:227], v12 offset:4608
    ds_read_b64_tr_b16 v[228:229], v13 offset:4096
    v_mfma_f32_32x32x16_bf16 v[80:95], v[192:195], v[204:207], v[80:95]
    ds_read_b64_tr_b16 v[230:231], v13 offset:4608
    ds_read_b128 v[232:235], v14 offset:256
    ds_read_b128 v[236:239], v15 offset:28928
    s_add_u32 s42, s76, 745472
    v_mfma_f32_32x32x16_bf16 v[96:111], v[196:199], v[200:203], v[96:111]
    buffer_load_dwordx4 v27, s[48:51], s42 offen lds
    v_mfma_f32_32x32x16_bf16 v[112:127], v[196:199], v[204:207], v[112:127]
    buffer_load_dwordx4 v28, s[48:51], s42 offen offset:1024 lds
    v_mfma_f32_32x32x16_bf16 v[64:79], v[208:211], v[216:219], v[64:79]
    s_waitcnt vmcnt(8) lgkmcnt(0)
    s_mov_b32 m0, s8
    ds_read_b64_tr_b16 v[192:193], v12 offset:6144
    ds_read_b64_tr_b16 v[194:195], v12 offset:6656
    ds_read_b64_tr_b16 v[196:197], v13 offset:6144
    v_mfma_f32_32x32x16_bf16 v[80:95], v[208:211], v[220:223], v[80:95]
    ds_read_b64_tr_b16 v[198:199], v13 offset:6656
    ds_read_b128 v[200:203], v15 offset:256
    ds_read_b128 v[204:207], v14 offset:28928
    s_add_u32 s42, s76, 802816
    v_mfma_f32_32x32x16_bf16 v[96:111], v[212:215], v[216:219], v[96:111]
    buffer_load_dwordx4 v27, s[48:51], s42 offen lds
    v_mfma_f32_32x32x16_bf16 v[112:127], v[212:215], v[220:223], v[112:127]
    buffer_load_dwordx4 v28, s[48:51], s42 offen offset:1024 lds
    v_mfma_f32_32x32x16_bf16 v[64:79], v[224:227], v[232:235], v[64:79]
    s_waitcnt vmcnt(8) lgkmcnt(0)
    s_mov_b32 m0, s9
    ds_read_b64_tr_b16 v[208:209], v12 offset:8192
    ds_read_b64_tr_b16 v[210:211], v12 offset:8704
    ds_read_b64_tr_b16 v[212:213], v13 offset:8192
    v_mfma_f32_32x32x16_bf16 v[80:95], v[224:227], v[236:239], v[80:95]
    ds_read_b64_tr_b16 v[214:215], v13 offset:8704
    ds_read_b128 v[216:219], v16 offset:256
    ds_read_b128 v[220:223], v17 offset:28928
    s_add_u32 s42, s76, 860160
    v_mfma_f32_32x32x16_bf16 v[96:111], v[228:231], v[232:235], v[96:111]
    buffer_load_dwordx4 v27, s[48:51], s42 offen lds
    v_mfma_f32_32x32x16_bf16 v[112:127], v[228:231], v[236:239], v[112:127]
    buffer_load_dwordx4 v28, s[48:51], s42 offen offset:1024 lds
    v_mfma_f32_32x32x16_bf16 v[64:79], v[192:195], v[200:203], v[64:79]
    s_waitcnt vmcnt(8) lgkmcnt(0)
    s_mov_b32 m0, s10
    ds_read_b64_tr_b16 v[224:225], v12 offset:10240
    ds_read_b64_tr_b16 v[226:227], v12 offset:10752
    ds_read_b64_tr_b16 v[228:229], v13 offset:10240
    v_mfma_f32_32x32x16_bf16 v[80:95], v[192:195], v[204:207], v[80:95]
    ds_read_b64_tr_b16 v[230:231], v13 offset:10752
    ds_read_b128 v[232:235], v17 offset:256
    ds_read_b128 v[236:239], v16 offset:28928
    s_add_u32 s42, s76, 917504
    v_mfma_f32_32x32x16_bf16 v[96:111], v[196:199], v[200:203], v[96:111]
    buffer_load_dwordx4 v27, s[48:51], s42 offen lds
    v_mfma_f32_32x32x16_bf16 v[112:127], v[196:199], v[204:207], v[112:127]
    buffer_load_dwordx4 v28, s[48:51], s42 offen offset:1024 lds
    v_mfma_f32_32x32x16_bf16 v[64:79], v[208:211], v[216:219], v[64:79]
    s_waitcnt vmcnt(8) lgkmcnt(0)
    s_mov_b32 m0, s11
    ds_read_b64_tr_b16 v[192:193], v12 offset:0
    ds_read_b64_tr_b16 v[194:195], v12 offset:512
    ds_read_b64_tr_b16 v[196:197], v13 offset:0
    v_mfma_f32_32x32x16_bf16 v[80:95], v[208:211], v[220:223], v[80:95]
    ds_read_b64_tr_b16 v[198:199], v13 offset:512
    ds_read_b128 v[200:203], v14 offset:384
    ds_read_b128 v[204:207], v15 offset:29056
    s_add_u32 s42, s76, 974848
    v_mfma_f32_32x32x16_bf16 v[96:111], v[212:215], v[216:219], v[96:111]
    buffer_load_dwordx4 v27, s[48:51], s42 offen lds
    v_mfma_f32_32x32x16_bf16 v[112:127], v[212:215], v[220:223], v[112:127]
    buffer_load_dwordx4 v28, s[48:51], s42 offen offset:1024 lds
    v_mfma_f32_32x32x16_bf16 v[64:79], v[224:227], v[232:235], v[64:79]
    s_waitcnt vmcnt(8) lgkmcnt(0)
    s_mov_b32 m0, s6
    ds_read_b64_tr_b16 v[208:209], v12 offset:2048
    ds_read_b64_tr_b16 v[210:211], v12 offset:2560
    ds_read_b64_tr_b16 v[212:213], v13 offset:2048
    v_mfma_f32_32x32x16_bf16 v[80:95], v[224:227], v[236:239], v[80:95]
    ds_read_b64_tr_b16 v[214:215], v13 offset:2560
    ds_read_b128 v[216:219], v15 offset:384
    ds_read_b128 v[220:223], v14 offset:29056
    s_add_u32 s42, s76, 1032192
    v_mfma_f32_32x32x16_bf16 v[96:111], v[228:231], v[232:235], v[96:111]
    buffer_load_dwordx4 v27, s[48:51], s42 offen lds
    v_mfma_f32_32x32x16_bf16 v[112:127], v[228:231], v[236:239], v[112:127]
    buffer_load_dwordx4 v28, s[48:51], s42 offen offset:1024 lds
    v_mfma_f32_32x32x16_bf16 v[64:79], v[192:195], v[200:203], v[64:79]
    s_waitcnt vmcnt(8) lgkmcnt(0)
    s_mov_b32 m0, s7
    ds_read_b64_tr_b16 v[224:225], v12 offset:4096
    ds_read_b64_tr_b16 v[226:227], v12 offset:4608
    ds_read_b64_tr_b16 v[228:229], v13 offset:4096
    v_mfma_f32_32x32x16_bf16 v[80:95], v[192:195], v[204:207], v[80:95]
    ds_read_b64_tr_b16 v[230:231], v13 offset:4608
    ds_read_b128 v[232:235], v16 offset:384
    ds_read_b128 v[236:239], v17 offset:29056
    s_add_u32 s42, s76, 1089536
    v_mfma_f32_32x32x16_bf16 v[96:111], v[196:199], v[200:203], v[96:111]
    buffer_load_dwordx4 v27, s[48:51], s42 offen lds
    v_mfma_f32_32x32x16_bf16 v[112:127], v[196:199], v[204:207], v[112:127]
    buffer_load_dwordx4 v28, s[48:51], s42 offen offset:1024 lds
    v_mfma_f32_32x32x16_bf16 v[64:79], v[208:211], v[216:219], v[64:79]
    s_waitcnt vmcnt(8) lgkmcnt(0)
    s_mov_b32 m0, s8
    ds_read_b64_tr_b16 v[192:193], v12 offset:6144
    ds_read_b64_tr_b16 v[194:195], v12 offset:6656
    ds_read_b64_tr_b16 v[196:197], v13 offset:6144
    v_mfma_f32_32x32x16_bf16 v[80:95], v[208:211], v[220:223], v[80:95]
    ds_read_b64_tr_b16 v[198:199], v13 offset:6656
    ds_read_b128 v[200:203], v17 offset:384
    ds_read_b128 v[204:207], v16 offset:29056
    s_add_u32 s42, s76, 1146880
    v_mfma_f32_32x32x16_bf16 v[96:111], v[212:215], v[216:219], v[96:111]
    buffer_load_dwordx4 v27, s[48:51], s42 offen lds
    v_mfma_f32_32x32x16_bf16 v[112:127], v[212:215], v[220:223], v[112:127]
    buffer_load_dwordx4 v28, s[48:51], s42 offen offset:1024 lds
    v_mfma_f32_32x32x16_bf16 v[64:79], v[224:227], v[232:235], v[64:79]
    s_waitcnt vmcnt(8) lgkmcnt(0)
    s_mov_b32 m0, s9
    ds_read_b64_tr_b16 v[208:209], v12 offset:8192
    ds_read_b64_tr_b16 v[210:211], v12 offset:8704
    ds_read_b64_tr_b16 v[212:213], v13 offset:8192
    v_mfma_f32_32x32x16_bf16 v[80:95], v[224:227], v[236:239], v[80:95]
    ds_read_b64_tr_b16 v[214:215], v13 offset:8704
    ds_read_b128 v[216:219], v14 offset:512
    ds_read_b128 v[220:223], v15 offset:29184
    s_add_u32 s42, s76, 1204224
    v_mfma_f32_32x32x16_bf16 v[96:111], v[228:231], v[232:235], v[96:111]
    buffer_load_dwordx4 v27, s[48:51], s42 offen lds
    v_mfma_f32_32x32x16_bf16 v[112:127], v[228:231], v[236:239], v[112:127]
    buffer_load_dwordx4 v28, s[48:51], s42 offen offset:1024 lds
    v_mfma_f32_32x32x16_bf16 v[64:79], v[192:195], v[200:203], v[64:79]
    s_waitcnt vmcnt(8) lgkmcnt(0)
    s_mov_b32 m0, s10
    ds_read_b64_tr_b16 v[224:225], v12 offset:10240
    ds_read_b64_tr_b16 v[226:227], v12 offset:10752
    ds_read_b64_tr_b16 v[228:229], v13 offset:10240
    v_mfma_f32_32x32x16_bf16 v[80:95], v[192:195], v[204:207], v[80:95]
    ds_read_b64_tr_b16 v[230:231], v13 offset:10752
    ds_read_b128 v[232:235], v15 offset:512
    ds_read_b128 v[236:239], v14 offset:29184
    s_add_u32 s42, s76, 1261568
    v_mfma_f32_32x32x16_bf16 v[96:111], v[196:199], v[200:203], v[96:111]
    buffer_load_dwordx4 v27, s[48:51], s42 offen lds
    v_mfma_f32_32x32x16_bf16 v[112:127], v[196:199], v[204:207], v[112:127]
    buffer_load_dwordx4 v28, s[48:51], s42 offen offset:1024 lds
    v_mfma_f32_32x32x16_bf16 v[64:79], v[208:211], v[216:219], v[64:79]
    s_waitcnt vmcnt(8) lgkmcnt(0)
    s_mov_b32 m0, s11
    ds_read_b64_tr_b16 v[192:193], v12 offset:0
    ds_read_b64_tr_b16 v[194:195], v12 offset:512
    ds_read_b64_tr_b16 v[196:197], v13 offset:0
    v_mfma_f32_32x32x16_bf16 v[80:95], v[208:211], v[220:223], v[80:95]
    ds_read_b64_tr_b16 v[198:199], v13 offset:512
    ds_read_b128 v[200:203], v16 offset:512
    ds_read_b128 v[204:207], v17 offset:29184
    s_add_u32 s42, s76, 1318912
    v_mfma_f32_32x32x16_bf16 v[96:111], v[212:215], v[216:219], v[96:111]
    buffer_load_dwordx4 v27, s[48:51], s42 offen lds
    v_mfma_f32_32x32x16_bf16 v[112:127], v[212:215], v[220:223], v[112:127]
    buffer_load_dwordx4 v28, s[48:51], s42 offen offset:1024 lds
    v_mfma_f32_32x32x16_bf16 v[64:79], v[224:227], v[232:235], v[64:79]
    s_waitcnt vmcnt(8) lgkmcnt(0)
    s_mov_b32 m0, s6
    ds_read_b64_tr_b16 v[208:209], v12 offset:2048
    ds_read_b64_tr_b16 v[210:211], v12 offset:2560
    ds_read_b64_tr_b16 v[212:213], v13 offset:2048
    v_mfma_f32_32x32x16_bf16 v[80:95], v[224:227], v[236:239], v[80:95]
    ds_read_b64_tr_b16 v[214:215], v13 offset:2560
    ds_read_b128 v[216:219], v17 offset:512
    ds_read_b128 v[220:223], v16 offset:29184
    s_add_u32 s42, s76, 1376256
    v_mfma_f32_32x32x16_bf16 v[96:111], v[228:231], v[232:235], v[96:111]
    buffer_load_dwordx4 v27, s[48:51], s42 offen lds
    v_mfma_f32_32x32x16_bf16 v[112:127], v[228:231], v[236:239], v[112:127]
    buffer_load_dwordx4 v28, s[48:51], s42 offen offset:1024 lds
    v_mfma_f32_32x32x16_bf16 v[64:79], v[192:195], v[200:203], v[64:79]
    s_waitcnt vmcnt(8) lgkmcnt(0)
    s_mov_b32 m0, s7
    ds_read_b64_tr_b16 v[224:225], v12 offset:4096
    ds_read_b64_tr_b16 v[226:227], v12 offset:4608
    ds_read_b64_tr_b16 v[228:229], v13 offset:4096
    v_mfma_f32_32x32x16_bf16 v[80:95], v[192:195], v[204:207], v[80:95]
    ds_read_b64_tr_b16 v[230:231], v13 offset:4608
    ds_read_b128 v[232:235], v14 offset:640
    ds_read_b128 v[236:239], v15 offset:29312
    s_add_u32 s42, s76, 1433600
    v_mfma_f32_32x32x16_bf16 v[96:111], v[196:199], v[200:203], v[96:111]
    buffer_load_dwordx4 v27, s[48:51], s42 offen lds
    v_mfma_f32_32x32x16_bf16 v[112:127], v[196:199], v[204:207], v[112:127]
    buffer_load_dwordx4 v28, s[48:51], s42 offen offset:1024 lds
    v_mfma_f32_32x32x16_bf16 v[64:79], v[208:211], v[216:219], v[64:79]
    s_waitcnt vmcnt(8) lgkmcnt(0)
    s_mov_b32 m0, s8
    ds_read_b64_tr_b16 v[192:193], v12 offset:6144
    ds_read_b64_tr_b16 v[194:195], v12 offset:6656
    ds_read_b64_tr_b16 v[196:197], v13 offset:6144
    v_mfma_f32_32x32x16_bf16 v[80:95], v[208:211], v[220:223], v[80:95]
    ds_read_b64_tr_b16 v[198:199], v13 offset:6656
    ds_read_b128 v[200:203], v15 offset:640
    ds_read_b128 v[204:207], v14 offset:29312
    s_add_u32 s42, s76, 1490944
    v_mfma_f32_32x32x16_bf16 v[96:111], v[212:215], v[216:219], v[96:111]
    buffer_load_dwordx4 v27, s[48:51], s42 offen lds
    v_mfma_f32_32x32x16_bf16 v[112:127], v[212:215], v[220:223], v[112:127]
    buffer_load_dwordx4 v28, s[48:51], s42 offen offset:1024 lds
    v_mfma_f32_32x32x16_bf16 v[64:79], v[224:227], v[232:235], v[64:79]
    s_waitcnt vmcnt(8) lgkmcnt(0)
    s_mov_b32 m0, s9
    ds_read_b64_tr_b16 v[208:209], v12 offset:8192
    ds_read_b64_tr_b16 v[210:211], v12 offset:8704
    ds_read_b64_tr_b16 v[212:213], v13 offset:8192
    v_mfma_f32_32x32x16_bf16 v[80:95], v[224:227], v[236:239], v[80:95]
    ds_read_b64_tr_b16 v[214:215], v13 offset:8704
    ds_read_b128 v[216:219], v16 offset:640
    ds_read_b128 v[220:223], v17 offset:29312
    s_add_u32 s42, s76, 1548288
    v_mfma_f32_32x32x16_bf16 v[96:111], v[228:231], v[232:235], v[96:111]
    buffer_load_dwordx4 v27, s[48:51], s42 offen lds
    v_mfma_f32_32x32x16_bf16 v[112:127], v[228:231], v[236:239], v[112:127]
    buffer_load_dwordx4 v28, s[48:51], s42 offen offset:1024 lds
    v_mfma_f32_32x32x16_bf16 v[64:79], v[192:195], v[200:203], v[64:79]
    s_waitcnt vmcnt(8) lgkmcnt(0)
    s_mov_b32 m0, s16
    ds_read_b64_tr_b16 v[224:225], v12 offset:10240
    ds_read_b64_tr_b16 v[226:227], v12 offset:10752
    ds_read_b64_tr_b16 v[228:229], v13 offset:10240
    v_mfma_f32_32x32x16_bf16 v[80:95], v[192:195], v[204:207], v[80:95]
    ds_read_b64_tr_b16 v[230:231], v13 offset:10752
    ds_read_b128 v[232:235], v17 offset:640
    ds_read_b128 v[236:239], v16 offset:29312
    s_add_u32 s42, s80, 0
    s_nop 0
    v_mfma_f32_32x32x16_bf16 v[96:111], v[196:199], v[200:203], v[96:111]
    buffer_load_dwordx4 v29, s[52:55], s42 offen lds
    v_mfma_f32_32x32x16_bf16 v[112:127], v[196:199], v[204:207], v[112:127]
    buffer_load_dwordx4 v30, s[52:55], s42 offen offset:1024 lds
    v_mfma_f32_32x32x16_bf16 v[64:79], v[208:211], v[216:219], v[64:79]
    s_waitcnt vmcnt(8) lgkmcnt(0)
    s_mov_b32 m0, s17
    ds_read_b64_tr_b16 v[192:193], v12 offset:0
    ds_read_b64_tr_b16 v[194:195], v12 offset:512
    ds_read_b64_tr_b16 v[196:197], v13 offset:0
    v_mfma_f32_32x32x16_bf16 v[80:95], v[208:211], v[220:223], v[80:95]
    ds_read_b64_tr_b16 v[198:199], v13 offset:512
    ds_read_b128 v[200:203], v14 offset:768
    ds_read_b128 v[204:207], v15 offset:29440
    s_add_u32 s42, s80, 14336
    v_mfma_f32_32x32x16_bf16 v[96:111], v[212:215], v[216:219], v[96:111]
    buffer_load_dwordx4 v29, s[52:55], s42 offen lds
    v_mfma_f32_32x32x16_bf16 v[112:127], v[212:215], v[220:223], v[112:127]
    buffer_load_dwordx4 v30, s[52:55], s42 offen offset:1024 lds
    v_mfma_f32_32x32x16_bf16 v[64:79], v[224:227], v[232:235], v[64:79]
    s_waitcnt vmcnt(8) lgkmcnt(0)
    s_mov_b32 m0, s12
    ds_read_b64_tr_b16 v[208:209], v12 offset:2048
    ds_read_b64_tr_b16 v[210:211], v12 offset:2560
    ds_read_b64_tr_b16 v[212:213], v13 offset:2048
    v_mfma_f32_32x32x16_bf16 v[80:95], v[224:227], v[236:239], v[80:95]
    ds_read_b64_tr_b16 v[214:215], v13 offset:2560
    ds_read_b128 v[216:219], v15 offset:768
    ds_read_b128 v[220:223], v14 offset:29440
    s_add_u32 s42, s80, 28672
    v_mfma_f32_32x32x16_bf16 v[96:111], v[228:231], v[232:235], v[96:111]
    buffer_load_dwordx4 v29, s[52:55], s42 offen lds
    v_mfma_f32_32x32x16_bf16 v[112:127], v[228:231], v[236:239], v[112:127]
    buffer_load_dwordx4 v30, s[52:55], s42 offen offset:1024 lds
    v_mfma_f32_32x32x16_bf16 v[64:79], v[192:195], v[200:203], v[64:79]
    s_waitcnt vmcnt(8) lgkmcnt(0)
    s_mov_b32 m0, s13
    ds_read_b64_tr_b16 v[224:225], v12 offset:4096
    ds_read_b64_tr_b16 v[226:227], v12 offset:4608
    ds_read_b64_tr_b16 v[228:229], v13 offset:4096
    v_mfma_f32_32x32x16_bf16 v[80:95], v[192:195], v[204:207], v[80:95]
    ds_read_b64_tr_b16 v[230:231], v13 offset:4608
    ds_read_b128 v[232:235], v16 offset:768
    ds_read_b128 v[236:239], v17 offset:29440
    s_add_u32 s42, s80, 43008
    v_mfma_f32_32x32x16_bf16 v[96:111], v[196:199], v[200:203], v[96:111]
    buffer_load_dwordx4 v29, s[52:55], s42 offen lds
    v_mfma_f32_32x32x16_bf16 v[112:127], v[196:199], v[204:207], v[112:127]
    buffer_load_dwordx4 v30, s[52:55], s42 offen offset:1024 lds
    v_mfma_f32_32x32x16_bf16 v[64:79], v[208:211], v[216:219], v[64:79]
    s_waitcnt vmcnt(8) lgkmcnt(0)
    s_mov_b32 m0, s14
    ds_read_b64_tr_b16 v[192:193], v12 offset:6144
    ds_read_b64_tr_b16 v[194:195], v12 offset:6656
    ds_read_b64_tr_b16 v[196:197], v13 offset:6144
    v_mfma_f32_32x32x16_bf16 v[80:95], v[208:211], v[220:223], v[80:95]
    ds_read_b64_tr_b16 v[198:199], v13 offset:6656
    ds_read_b128 v[200:203], v17 offset:768
    ds_read_b128 v[204:207], v16 offset:29440
    s_add_u32 s42, s80, 57344
    v_mfma_f32_32x32x16_bf16 v[96:111], v[212:215], v[216:219], v[96:111]
    buffer_load_dwordx4 v29, s[52:55], s42 offen lds
    v_mfma_f32_32x32x16_bf16 v[112:127], v[212:215], v[220:223], v[112:127]
    buffer_load_dwordx4 v30, s[52:55], s42 offen offset:1024 lds
    v_mfma_f32_32x32x16_bf16 v[64:79], v[224:227], v[232:235], v[64:79]
    s_waitcnt lgkmcnt(0)
    s_mov_b32 m0, s15
    v_mfma_f32_32x32x16_bf16 v[80:95], v[224:227], v[236:239], v[80:95]
    s_add_u32 s42, s80, 71680
    v_mfma_f32_32x32x16_bf16 v[96:111], v[228:231], v[232:235], v[96:111]
    buffer_load_dwordx4 v29, s[52:55], s42 offen lds
    v_mfma_f32_32x32x16_bf16 v[112:127], v[228:231], v[236:239], v[112:127]
    buffer_load_dwordx4 v30, s[52:55], s42 offen offset:1024 lds
    v_mfma_f32_32x32x16_bf16 v[64:79], v[192:195], v[200:203], v[64:79]
    s_nop 0
    s_nop 0
    v_mfma_f32_32x32x16_bf16 v[80:95], v[192:195], v[204:207], v[80:95]
    v_mfma_f32_32x32x16_bf16 v[96:111], v[196:199], v[200:203], v[96:111]
    v_mfma_f32_32x32x16_bf16 v[112:127], v[196:199], v[204:207], v[112:127]
    s_waitcnt lgkmcnt(0)
    v_mov_b32 v2, 158216
    v_mov_b32 v3, 1
    s_mov_b64 exec, 1
    ds_add_u32 v2, v3
    s_mov_b64 exec, -1
    v_mov_b32 v2, 158208
K1_SPIN2:
    ds_read_b32 v3, v2
    s_waitcnt lgkmcnt(0)
    v_readfirstlane_b32 s42, v3
    s_nop 2
    s_cmp_ge_u32 s42, 4
    s_cbranch_scc0 K1_SPIN2_S
    s_setprio 0
    v_mov_b32 v56, 0xc0135761
    v_mov_b32 v57, 0xc0135761
    v_mov_b32 v58, 0xbdd2d3e8
    v_mov_b32 v59, 0xbdd2d3e8
    v_mov_b32 v62, 1.0
    v_mov_b32 v63, 1.0
    s_mul_i32 s82, s40, 12288
    s_add_u32 s82, s82, 57344
    v_lshlrev_b32 v61, 4, v1
    v_add_u32 v61, s82, v61
    v_pk_mul_f32 v[32:33], v[64:65], v[64:65]
    v_pk_mul_f32 v[34:35], v[66:67], v[66:67]
    v_pk_mul_f32 v[36:37], v[68:69], v[68:69]
    v_pk_mul_f32 v[38:39], v[70:71], v[70:71]
    v_pk_mul_f32 v[40:41], v[72:73], v[72:73]
    v_pk_mul_f32 v[42:43], v[74:75], v[74:75]
    v_pk_mul_f32 v[44:45], v[76:77], v[76:77]
    v_pk_mul_f32 v[46:47], v[78:79], v[78:79]
    v_pk_fma_f32 v[32:33], v[32:33], v[58:59], v[56:57]
    v_pk_fma_f32 v[34:35], v[34:35], v[58:59], v[56:57]
    v_pk_fma_f32 v[36:37], v[36:37], v[58:59], v[56:57]
    v_pk_fma_f32 v[38:39], v[38:39], v[58:59], v[56:57]
    v_pk_fma_f32 v[40:41], v[40:41], v[58:59], v[56:57]
    v_pk_fma_f32 v[42:43], v[42:43], v[58:59], v[56:57]
    v_pk_fma_f32 v[44:45], v[44:45], v[58:59], v[56:57]
    v_pk_fma_f32 v[46:47], v[46:47], v[58:59], v[56:57]
    v_pk_mul_f32 v[32:33], v[32:33], v[64:65]
    v_pk_mul_f32 v[34:35], v[34:35], v[66:67]
    v_pk_mul_f32 v[36:37], v[36:37], v[68:69]
    v_pk_mul_f32 v[38:39], v[38:39], v[70:71]
    v_pk_mul_f32 v[40:41], v[40:41], v[72:73]
    v_pk_mul_f32 v[42:43], v[42:43], v[74:75]
    v_pk_mul_f32 v[44:45], v[44:45], v[76:77]
    v_pk_mul_f32 v[46:47], v[46:47], v[78:79]
    v_exp_f32 v32, v32
    v_exp_f32 v33, v33
    v_exp_f32 v34, v34
    v_exp_f32 v35, v35
    v_exp_f32 v36, v36
    v_exp_f32 v37, v37
    v_exp_f32 v38, v38
    v_exp_f32 v39, v39
    v_exp_f32 v40, v40
    v_exp_f32 v41, v41
    v_exp_f32 v42, v42
    v_exp_f32 v43, v43
    v_exp_f32 v44, v44
    v_exp_f32 v45, v45
    v_exp_f32 v46, v46
    v_exp_f32 v47, v47
    v_pk_add_f32 v[32:33], v[32:33], v[62:63]
    v_pk_add_f32 v[34:35], v[34:35], v[62:63]
    v_pk_add_f32 v[36:37], v[36:37], v[62:63]
    v_pk_add_f32 v[38:39], v[38:39], v[62:63]
    v_pk_add_f32 v[40:41], v[40:41], v[62:63]
    v_pk_add_f32 v[42:43], v[42:43], v[62:63]
    v_pk_add_f32 v[44:45], v[44:45], v[62:63]
    v_pk_add_f32 v[46:47], v[46:47], v[62:63]
    v_rcp_f32 v32, v32
    v_rcp_f32 v33, v33
    v_rcp_f32 v34, v34
    v_rcp_f32 v35, v35
    v_rcp_f32 v36, v36
    v_rcp_f32 v37, v37
    v_rcp_f32 v38, v38
    v_rcp_f32 v39, v39
    v_rcp_f32 v40, v40
    v_rcp_f32 v41, v41
    v_rcp_f32 v42, v42
    v_rcp_f32 v43, v43
    v_rcp_f32 v44, v44
    v_rcp_f32 v45, v45
    v_rcp_f32 v46, v46
    v_rcp_f32 v47, v47
    v_pk_mul_f32 v[32:33], v[32:33], v[64:65]
    v_pk_mul_f32 v[34:35], v[34:35], v[66:67]
    v_pk_mul_f32 v[36:37], v[36:37], v[68:69]
    v_pk_mul_f32 v[38:39], v[38:39], v[70:71]
    v_pk_mul_f32 v[40:41], v[40:41], v[72:73]
    v_pk_mul_f32 v[42:43], v[42:43], v[74:75]
    v_pk_mul_f32 v[44:45], v[44:45], v[76:77]
    v_pk_mul_f32 v[46:47], v[46:47], v[78:79]
    v_cvt_pk_bf16_f32 v48, v32, v33
    v_cvt_pk_bf16_f32 v49, v34, v35
    v_cvt_pk_bf16_f32 v50, v36, v37
    v_cvt_pk_bf16_f32 v51, v38, v39
    ds_write_b128 v61, v[48:51] offset:0
    v_cvt_pk_bf16_f32 v52, v40, v41
    v_cvt_pk_bf16_f32 v53, v42, v43
    v_cvt_pk_bf16_f32 v54, v44, v45
    v_cvt_pk_bf16_f32 v55, v46, v47
    ds_write_b128 v61, v[52:55] offset:2048
    v_pk_mul_f32 v[32:33], v[80:81], v[80:81]
    v_pk_mul_f32 v[34:35], v[82:83], v[82:83]
    v_pk_mul_f32 v[36:37], v[84:85], v[84:85]
    v_pk_mul_f32 v[38:39], v[86:87], v[86:87]
    v_pk_mul_f32 v[40:41], v[88:89], v[88:89]
    v_pk_mul_f32 v[42:43], v[90:91], v[90:91]
    v_pk_mul_f32 v[44:45], v[92:93], v[92:93]
    v_pk_mul_f32 v[46:47], v[94:95], v[94:95]
    v_pk_fma_f32 v[32:33], v[32:33], v[58:59], v[56:57]
    v_pk_fma_f32 v[34:35], v[34:35], v[58:59], v[56:57]
    v_pk_fma_f32 v[36:37], v[36:37], v[58:59], v[56:57]
    v_pk_fma_f32 v[38:39], v[38:39], v[58:59], v[56:57]
    v_pk_fma_f32 v[40:41], v[40:41], v[58:59], v[56:57]
    v_pk_fma_f32 v[42:43], v[42:43], v[58:59], v[56:57]
    v_pk_fma_f32 v[44:45], v[44:45], v[58:59], v[56:57]
    v_pk_fma_f32 v[46:47], v[46:47], v[58:59], v[56:57]
    v_pk_mul_f32 v[32:33], v[32:33], v[80:81]
    v_pk_mul_f32 v[34:35], v[34:35], v[82:83]
    v_pk_mul_f32 v[36:37], v[36:37], v[84:85]
    v_pk_mul_f32 v[38:39], v[38:39], v[86:87]
    v_pk_mul_f32 v[40:41], v[40:41], v[88:89]
    v_pk_mul_f32 v[42:43], v[42:43], v[90:91]
    v_pk_mul_f32 v[44:45], v[44:45], v[92:93]
    v_pk_mul_f32 v[46:47], v[46:47], v[94:95]
    v_exp_f32 v32, v32
    v_exp_f32 v33, v33
    v_exp_f32 v34, v34
    v_exp_f32 v35, v35
    v_exp_f32 v36, v36
    v_exp_f32 v37, v37
    v_exp_f32 v38, v38
    v_exp_f32 v39, v39
    v_exp_f32 v40, v40
    v_exp_f32 v41, v41
    v_exp_f32 v42, v42
    v_exp_f32 v43, v43
    v_exp_f32 v44, v44
    v_exp_f32 v45, v45
    v_exp_f32 v46, v46
    v_exp_f32 v47, v47
    v_pk_add_f32 v[32:33], v[32:33], v[62:63]
    v_pk_add_f32 v[34:35], v[34:35], v[62:63]
    v_pk_add_f32 v[36:37], v[36:37], v[62:63]
    v_pk_add_f32 v[38:39], v[38:39], v[62:63]
    v_pk_add_f32 v[40:41], v[40:41], v[62:63]
    v_pk_add_f32 v[42:43], v[42:43], v[62:63]
    v_pk_add_f32 v[44:45], v[44:45], v[62:63]
    v_pk_add_f32 v[46:47], v[46:47], v[62:63]
    v_rcp_f32 v32, v32
    v_rcp_f32 v33, v33
    v_rcp_f32 v34, v34
    v_rcp_f32 v35, v35
    v_rcp_f32 v36, v36
    v_rcp_f32 v37, v37
    v_rcp_f32 v38, v38
    v_rcp_f32 v39, v39
    v_rcp_f32 v40, v40
    v_rcp_f32 v41, v41
    v_rcp_f32 v42, v42
    v_rcp_f32 v43, v43
    v_rcp_f32 v44, v44
    v_rcp_f32 v45, v45
    v_rcp_f32 v46, v46
    v_rcp_f32 v47, v47
    v_pk_mul_f32 v[32:33], v[32:33], v[80:81]
    v_pk_mul_f32 v[34:35], v[34:35], v[82:83]
    v_pk_mul_f32 v[36:37], v[36:37], v[84:85]
    v_pk_mul_f32 v[38:39], v[38:39], v[86:87]
    v_pk_mul_f32 v[40:41], v[40:41], v[88:89]
    v_pk_mul_f32 v[42:43], v[42:43], v[90:91]
    v_pk_mul_f32 v[44:45], v[44:45], v[92:93]
    v_pk_mul_f32 v[46:47], v[46:47], v[94:95]
    v_cvt_pk_bf16_f32 v48, v32, v33
    v_cvt_pk_bf16_f32 v49, v34, v35
    v_cvt_pk_bf16_f32 v50, v36, v37
    v_cvt_pk_bf16_f32 v51, v38, v39
    ds_write_b128 v61, v[48:51] offset:1024
    v_cvt_pk_bf16_f32 v52, v40, v41
    v_cvt_pk_bf16_f32 v53, v42, v43
    v_cvt_pk_bf16_f32 v54, v44, v45
    v_cvt_pk_bf16_f32 v55, v46, v47
    ds_write_b128 v61, v[52:55] offset:3072
    v_pk_mul_f32 v[32:33], v[96:97], v[96:97]
    v_pk_mul_f32 v[34:35], v[98:99], v[98:99]
    v_pk_mul_f32 v[36:37], v[100:101], v[100:101]
    v_pk_mul_f32 v[38:39], v[102:103], v[102:103]
    v_pk_mul_f32 v[40:41], v[104:105], v[104:105]
    v_pk_mul_f32 v[42:43], v[106:107], v[106:107]
    v_pk_mul_f32 v[44:45], v[108:109], v[108:109]
    v_pk_mul_f32 v[46:47], v[110:111], v[110:111]
    v_pk_fma_f32 v[32:33], v[32:33], v[58:59], v[56:57]
    v_pk_fma_f32 v[34:35], v[34:35], v[58:59], v[56:57]
    v_pk_fma_f32 v[36:37], v[36:37], v[58:59], v[56:57]
    v_pk_fma_f32 v[38:39], v[38:39], v[58:59], v[56:57]
    v_pk_fma_f32 v[40:41], v[40:41], v[58:59], v[56:57]
    v_pk_fma_f32 v[42:43], v[42:43], v[58:59], v[56:57]
    v_pk_fma_f32 v[44:45], v[44:45], v[58:59], v[56:57]
    v_pk_fma_f32 v[46:47], v[46:47], v[58:59], v[56:57]
    v_pk_mul_f32 v[32:33], v[32:33], v[96:97]
    v_pk_mul_f32 v[34:35], v[34:35], v[98:99]
    v_pk_mul_f32 v[36:37], v[36:37], v[100:101]
    v_pk_mul_f32 v[38:39], v[38:39], v[102:103]
    v_pk_mul_f32 v[40:41], v[40:41], v[104:105]
    v_pk_mul_f32 v[42:43], v[42:43], v[106:107]
    v_pk_mul_f32 v[44:45], v[44:45], v[108:109]
    v_pk_mul_f32 v[46:47], v[46:47], v[110:111]
    v_exp_f32 v32, v32
    v_exp_f32 v33, v33
    v_exp_f32 v34, v34
    v_exp_f32 v35, v35
    v_exp_f32 v36, v36
    v_exp_f32 v37, v37
    v_exp_f32 v38, v38
    v_exp_f32 v39, v39
    v_exp_f32 v40, v40
    v_exp_f32 v41, v41
    v_exp_f32 v42, v42
    v_exp_f32 v43, v43
    v_exp_f32 v44, v44
    v_exp_f32 v45, v45
    v_exp_f32 v46, v46
    v_exp_f32 v47, v47
    v_pk_add_f32 v[32:33], v[32:33], v[62:63]
    v_pk_add_f32 v[34:35], v[34:35], v[62:63]
    v_pk_add_f32 v[36:37], v[36:37], v[62:63]
    v_pk_add_f32 v[38:39], v[38:39], v[62:63]
    v_pk_add_f32 v[40:41], v[40:41], v[62:63]
    v_pk_add_f32 v[42:43], v[42:43], v[62:63]
    v_pk_add_f32 v[44:45], v[44:45], v[62:63]
    v_pk_add_f32 v[46:47], v[46:47], v[62:63]
    v_rcp_f32 v32, v32
    v_rcp_f32 v33, v33
    v_rcp_f32 v34, v34
    v_rcp_f32 v35, v35
    v_rcp_f32 v36, v36
    v_rcp_f32 v37, v37
    v_rcp_f32 v38, v38
    v_rcp_f32 v39, v39
    v_rcp_f32 v40, v40
    v_rcp_f32 v41, v41
    v_rcp_f32 v42, v42
    v_rcp_f32 v43, v43
    v_rcp_f32 v44, v44
    v_rcp_f32 v45, v45
    v_rcp_f32 v46, v46
    v_rcp_f32 v47, v47
    v_pk_mul_f32 v[32:33], v[32:33], v[96:97]
    v_pk_mul_f32 v[34:35], v[34:35], v[98:99]
    v_pk_mul_f32 v[36:37], v[36:37], v[100:101]
    v_pk_mul_f32 v[38:39], v[38:39], v[102:103]
    v_pk_mul_f32 v[40:41], v[40:41], v[104:105]
    v_pk_mul_f32 v[42:43], v[42:43], v[106:107]
    v_pk_mul_f32 v[44:45], v[44:45], v[108:109]
    v_pk_mul_f32 v[46:47], v[46:47], v[110:111]
    v_cvt_pk_bf16_f32 v48, v32, v33
    v_cvt_pk_bf16_f32 v49, v34, v35
    v_cvt_pk_bf16_f32 v50, v36, v37
    v_cvt_pk_bf16_f32 v51, v38, v39
    ds_write_b128 v61, v[48:51] offset:4096
    v_cvt_pk_bf16_f32 v52, v40, v41
    v_cvt_pk_bf16_f32 v53, v42, v43
    v_cvt_pk_bf16_f32 v54, v44, v45
    v_cvt_pk_bf16_f32 v55, v46, v47
    ds_write_b128 v61, v[52:55] offset:6144
    v_pk_mul_f32 v[32:33], v[112:113], v[112:113]
    v_pk_mul_f32 v[34:35], v[114:115], v[114:115]
    v_pk_mul_f32 v[36:37], v[116:117], v[116:117]
    v_pk_mul_f32 v[38:39], v[118:119], v[118:119]
    v_pk_mul_f32 v[40:41], v[120:121], v[120:121]
    v_pk_mul_f32 v[42:43], v[122:123], v[122:123]
    v_pk_mul_f32 v[44:45], v[124:125], v[124:125]
    v_pk_mul_f32 v[46:47], v[126:127], v[126:127]
    v_pk_fma_f32 v[32:33], v[32:33], v[58:59], v[56:57]
    v_pk_fma_f32 v[34:35], v[34:35], v[58:59], v[56:57]
    v_pk_fma_f32 v[36:37], v[36:37], v[58:59], v[56:57]
    v_pk_fma_f32 v[38:39], v[38:39], v[58:59], v[56:57]
    v_pk_fma_f32 v[40:41], v[40:41], v[58:59], v[56:57]
    v_pk_fma_f32 v[42:43], v[42:43], v[58:59], v[56:57]
    v_pk_fma_f32 v[44:45], v[44:45], v[58:59], v[56:57]
    v_pk_fma_f32 v[46:47], v[46:47], v[58:59], v[56:57]
    v_pk_mul_f32 v[32:33], v[32:33], v[112:113]
    v_pk_mul_f32 v[34:35], v[34:35], v[114:115]
    v_pk_mul_f32 v[36:37], v[36:37], v[116:117]
    v_pk_mul_f32 v[38:39], v[38:39], v[118:119]
    v_pk_mul_f32 v[40:41], v[40:41], v[120:121]
    v_pk_mul_f32 v[42:43], v[42:43], v[122:123]
    v_pk_mul_f32 v[44:45], v[44:45], v[124:125]
    v_pk_mul_f32 v[46:47], v[46:47], v[126:127]
    v_exp_f32 v32, v32
    v_exp_f32 v33, v33
    v_exp_f32 v34, v34
    v_exp_f32 v35, v35
    v_exp_f32 v36, v36
    v_exp_f32 v37, v37
    v_exp_f32 v38, v38
    v_exp_f32 v39, v39
    v_exp_f32 v40, v40
    v_exp_f32 v41, v41
    v_exp_f32 v42, v42
    v_exp_f32 v43, v43
    v_exp_f32 v44, v44
    v_exp_f32 v45, v45
    v_exp_f32 v46, v46
    v_exp_f32 v47, v47
    v_pk_add_f32 v[32:33], v[32:33], v[62:63]
    v_pk_add_f32 v[34:35], v[34:35], v[62:63]
    v_pk_add_f32 v[36:37], v[36:37], v[62:63]
    v_pk_add_f32 v[38:39], v[38:39], v[62:63]
    v_pk_add_f32 v[40:41], v[40:41], v[62:63]
    v_pk_add_f32 v[42:43], v[42:43], v[62:63]
    v_pk_add_f32 v[44:45], v[44:45], v[62:63]
    v_pk_add_f32 v[46:47], v[46:47], v[62:63]
    v_rcp_f32 v32, v32
    v_rcp_f32 v33, v33
    v_rcp_f32 v34, v34
    v_rcp_f32 v35, v35
    v_rcp_f32 v36, v36
    v_rcp_f32 v37, v37
    v_rcp_f32 v38, v38
    v_rcp_f32 v39, v39
    v_rcp_f32 v40, v40
    v_rcp_f32 v41, v41
    v_rcp_f32 v42, v42
    v_rcp_f32 v43, v43
    v_rcp_f32 v44, v44
    v_rcp_f32 v45, v45
    v_rcp_f32 v46, v46
    v_rcp_f32 v47, v47
    v_pk_mul_f32 v[32:33], v[32:33], v[112:113]
    v_pk_mul_f32 v[34:35], v[34:35], v[114:115]
    v_pk_mul_f32 v[36:37], v[36:37], v[116:117]
    v_pk_mul_f32 v[38:39], v[38:39], v[118:119]
    v_pk_mul_f32 v[40:41], v[40:41], v[120:121]
    v_pk_mul_f32 v[42:43], v[42:43], v[122:123]
    v_pk_mul_f32 v[44:45], v[44:45], v[124:125]
    v_pk_mul_f32 v[46:47], v[46:47], v[126:127]
    v_cvt_pk_bf16_f32 v48, v32, v33
    v_cvt_pk_bf16_f32 v49, v34, v35
    v_cvt_pk_bf16_f32 v50, v36, v37
    v_cvt_pk_bf16_f32 v51, v38, v39
    ds_write_b128 v61, v[48:51] offset:5120
    v_cvt_pk_bf16_f32 v52, v40, v41
    v_cvt_pk_bf16_f32 v53, v42, v43
    v_cvt_pk_bf16_f32 v54, v44, v45
    v_cvt_pk_bf16_f32 v55, v46, v47
    ds_write_b128 v61, v[52:55] offset:7168
    s_waitcnt lgkmcnt(0)
    s_waitcnt lgkmcnt(0)
    v_mov_b32 v2, 158236
    v_mov_b32 v3, 1
    s_mov_b64 exec, 1
    ds_add_u32 v2, v3
    s_mov_b64 exec, -1
    s_setprio 2
K1_G3:
    v_mov_b32 v2, 158236
K1_SPIN3:
    ds_read_b32 v3, v2
    s_waitcnt lgkmcnt(0)
    v_readfirstlane_b32 s42, v3
    s_nop 2
    s_cmp_ge_u32 s42, 4
    s_cbranch_scc0 K1_SPIN3_S
    s_waitcnt vmcnt(10)
    ds_read_b64_tr_b16 v[200:201], v18 offset:8192
    ds_read_b64_tr_b16 v[202:203], v18 offset:9216
    ds_read_b64_tr_b16 v[204:205], v19 offset:8192
    ds_read_b64_tr_b16 v[206:207], v19 offset:9216
    ds_read_b128 v[192:195], v20 offset:0
    ds_read_b128 v[196:199], v20 offset:1024
    s_waitcnt vmcnt(8)
    s_nop 0
    ds_read_b64_tr_b16 v[216:217], v18 offset:10240
    ds_read_b64_tr_b16 v[218:219], v18 offset:11264
    ds_read_b64_tr_b16 v[220:221], v19 offset:10240
    ds_read_b64_tr_b16 v[222:223], v19 offset:11264
    ds_read_b128 v[208:211], v20 offset:2048
    ds_read_b128 v[212:215], v20 offset:3072
    s_waitcnt lgkmcnt(6)
    v_mfma_f32_32x32x16_bf16 v[128:143], v[192:195], v[200:203], 0
    s_waitcnt vmcnt(6) lgkmcnt(0)
    s_mov_b32 m0, s16
    s_nop 0
    ds_read_b64_tr_b16 v[232:233], v18 offset:0
    ds_read_b64_tr_b16 v[234:235], v18 offset:1024
    ds_read_b64_tr_b16 v[236:237], v19 offset:0
    v_mfma_f32_32x32x16_bf16 v[144:159], v[192:195], v[204:207], 0
    ds_read_b64_tr_b16 v[238:239], v19 offset:1024
    ds_read_b128 v[224:227], v20 offset:4096
    ds_read_b128 v[228:231], v20 offset:5120
    s_add_u32 s42, s80, 86016
    v_mfma_f32_32x32x16_bf16 v[160:175], v[196:199], v[200:203], 0
    buffer_load_dwordx4 v29, s[52:55], s42 offen lds
    v_mfma_f32_32x32x16_bf16 v[176:191], v[196:199], v[204:207], 0
    buffer_load_dwordx4 v30, s[52:55], s42 offen offset:1024 lds
    s_mov_b32 m0, s17
    s_nop 0
    s_add_u32 s42, s80, 100352
    buffer_load_dwordx4 v29, s[52:55], s42 offen lds
    buffer_load_dwordx4 v30, s[52:55], s42 offen offset:1024 lds
    v_mfma_f32_32x32x16_bf16 v[128:143], v[208:211], v[216:219], v[128:143]
    s_waitcnt vmcnt(8) lgkmcnt(0)
    s_mov_b32 m0, s12
    ds_read_b64_tr_b16 v[200:201], v18 offset:2048
    ds_read_b64_tr_b16 v[202:203], v18 offset:3072
    ds_read_b64_tr_b16 v[204:205], v19 offset:2048
    v_mfma_f32_32x32x16_bf16 v[144:159], v[208:211], v[220:223], v[144:159]
    ds_read_b64_tr_b16 v[206:207], v19 offset:3072
    ds_read_b128 v[192:195], v20 offset:6144
    ds_read_b128 v[196:199], v20 offset:7168
    s_add_u32 s42, s80, 114688
    v_mfma_f32_32x32x16_bf16 v[160:175], v[212:215], v[216:219], v[160:175]
    buffer_load_dwordx4 v29, s[52:55], s42 offen lds
    v_mfma_f32_32x32x16_bf16 v[176:191], v[212:215], v[220:223], v[176:191]
    buffer_load_dwordx4 v30, s[52:55], s42 offen offset:1024 lds
    v_mfma_f32_32x32x16_bf16 v[128:143], v[224:227], v[232:235], v[128:143]
    s_waitcnt vmcnt(8) lgkmcnt(0)
    s_mov_b32 m0, s13
    ds_read_b64_tr_b16 v[216:217], v18 offset:4096
    ds_read_b64_tr_b16 v[218:219], v18 offset:5120
    ds_read_b64_tr_b16 v[220:221], v19 offset:4096
    v_mfma_f32_32x32x16_bf16 v[144:159], v[224:227], v[236:239], v[144:159]
    ds_read_b64_tr_b16 v[222:223], v19 offset:5120
    ds_read_b128 v[208:211], v20 offset:12288
    ds_read_b128 v[212:215], v20 offset:13312
    s_add_u32 s42, s80, 129024
    v_mfma_f32_32x32x16_bf16 v[160:175], v[228:231], v[232:235], v[160:175]
    buffer_load_dwordx4 v29, s[52:55], s42 offen lds
    v_mfma_f32_32x32x16_bf16 v[176:191], v[228:231], v[236:239], v[176:191]
    buffer_load_dwordx4 v30, s[52:55], s42 offen offset:1024 lds
    v_mfma_f32_32x32x16_bf16 v[128:143], v[192:195], v[200:203], v[128:143]
    s_waitcnt vmcnt(8) lgkmcnt(0)
    s_mov_b32 m0, s14
    ds_read_b64_tr_b16 v[232:233], v18 offset:6144
    ds_read_b64_tr_b16 v[234:235], v18 offset:7168
    ds_read_b64_tr_b16 v[236:237], v19 offset:6144
    v_mfma_f32_32x32x16_bf16 v[144:159], v[192:195], v[204:207], v[144:159]
    ds_read_b64_tr_b16 v[238:239], v19 offset:7168
    ds_read_b128 v[224:227], v20 offset:14336
    ds_read_b128 v[228:231], v20 offset:15360
    s_add_u32 s42, s80, 143360
    v_mfma_f32_32x32x16_bf16 v[160:175], v[196:199], v[200:203], v[160:175]
    buffer_load_dwordx4 v29, s[52:55], s42 offen lds
    v_mfma_f32_32x32x16_bf16 v[176:191], v[196:199], v[204:207], v[176:191]
    buffer_load_dwordx4 v30, s[52:55], s42 offen offset:1024 lds
    v_mfma_f32_32x32x16_bf16 v[128:143], v[208:211], v[216:219], v[128:143]
    s_waitcnt vmcnt(8) lgkmcnt(0)
    s_mov_b32 m0, s15
    ds_read_b64_tr_b16 v[200:201], v18 offset:8192
    ds_read_b64_tr_b16 v[202:203], v18 offset:9216
    ds_read_b64_tr_b16 v[204:205], v19 offset:8192
    v_mfma_f32_32x32x16_bf16 v[144:159], v[208:211], v[220:223], v[144:159]
    ds_read_b64_tr_b16 v[206:207], v19 offset:9216
    ds_read_b128 v[192:195], v20 offset:16384
    ds_read_b128 v[196:199], v20 offset:17408
    s_add_u32 s42, s80, 157696
    v_mfma_f32_32x32x16_bf16 v[160:175], v[212:215], v[216:219], v[160:175]
    buffer_load_dwordx4 v29, s[52:55], s42 offen lds
    v_mfma_f32_32x32x16_bf16 v[176:191], v[212:215], v[220:223], v[176:191]
    buffer_load_dwordx4 v30, s[52:55], s42 offen offset:1024 lds
    v_mfma_f32_32x32x16_bf16 v[128:143], v[224:227], v[232:235], v[128:143]
    s_waitcnt vmcnt(8) lgkmcnt(0)
    s_mov_b32 m0, s16
    ds_read_b64_tr_b16 v[216:217], v18 offset:10240
    ds_read_b64_tr_b16 v[218:219], v18 offset:11264
    ds_read_b64_tr_b16 v[220:221], v19 offset:10240
    v_mfma_f32_32x32x16_bf16 v[144:159], v[224:227], v[236:239], v[144:159]
    ds_read_b64_tr_b16 v[222:223], v19 offset:11264
    ds_read_b128 v[208:211], v20 offset:18432
    ds_read_b128 v[212:215], v20 offset:19456
    s_add_u32 s42, s80, 172032
    v_mfma_f32_32x32x16_bf16 v[160:175], v[228:231], v[232:235], v[160:175]
    buffer_load_dwordx4 v29, s[52:55], s42 offen lds
    v_mfma_f32_32x32x16_bf16 v[176:191], v[228:231], v[236:239], v[176:191]
    buffer_load_dwordx4 v30, s[52:55], s42 offen offset:1024 lds
    v_mfma_f32_32x32x16_bf16 v[128:143], v[192:195], v[200:203], v[128:143]
    s_waitcnt vmcnt(8) lgkmcnt(0)
    s_mov_b32 m0, s17
    ds_read_b64_tr_b16 v[232:233], v18 offset:0
    ds_read_b64_tr_b16 v[234:235], v18 offset:1024
    ds_read_b64_tr_b16 v[236:237], v19 offset:0
    v_mfma_f32_32x32x16_bf16 v[144:159], v[192:195], v[204:207], v[144:159]
    ds_read_b64_tr_b16 v[238:239], v19 offset:1024
    ds_read_b128 v[224:227], v20 offset:24576
    ds_read_b128 v[228:231], v20 offset:25600
    s_add_u32 s42, s80, 186368
    v_mfma_f32_32x32x16_bf16 v[160:175], v[196:199], v[200:203], v[160:175]
    buffer_load_dwordx4 v29, s[52:55], s42 offen lds
    v_mfma_f32_32x32x16_bf16 v[176:191], v[196:199], v[204:207], v[176:191]
    buffer_load_dwordx4 v30, s[52:55], s42 offen offset:1024 lds
    v_mfma_f32_32x32x16_bf16 v[128:143], v[208:211], v[216:219], v[128:143]
    s_waitcnt vmcnt(8) lgkmcnt(0)
    s_mov_b32 m0, s12
    ds_read_b64_tr_b16 v[200:201], v18 offset:2048
    ds_read_b64_tr_b16 v[202:203], v18 offset:3072
    ds_read_b64_tr_b16 v[204:205], v19 offset:2048
    v_mfma_f32_32x32x16_bf16 v[144:159], v[208:211], v[220:223], v[144:159]
    ds_read_b64_tr_b16 v[206:207], v19 offset:3072
    ds_read_b128 v[192:195], v20 offset:26624
    ds_read_b128 v[196:199], v20 offset:27648
    s_add_u32 s42, s80, 200704
    v_mfma_f32_32x32x16_bf16 v[160:175], v[212:215], v[216:219], v[160:175]
    buffer_load_dwordx4 v29, s[52:55], s42 offen lds
    v_mfma_f32_32x32x16_bf16 v[176:191], v[212:215], v[220:223], v[176:191]
    buffer_load_dwordx4 v30, s[52:55], s42 offen offset:1024 lds
    s_cmp_ge_u32 s40, 4
    s_cbranch_scc1 K1_PSW8
    s_setprio 1
    s_branch K1_PSWB8
K1_PSW8:
    s_setprio 1
K1_PSWB8:
    v_mfma_f32_32x32x16_bf16 v[128:143], v[224:227], v[232:235], v[128:143]
    s_waitcnt vmcnt(8) lgkmcnt(0)
    s_mov_b32 m0, s13
    s_nop 0
    ds_read_b64_tr_b16 v[216:217], v18 offset:4096
    ds_read_b64_tr_b16 v[218:219], v18 offset:5120
    ds_read_b64_tr_b16 v[220:221], v19 offset:4096
    v_mfma_f32_32x32x16_bf16 v[144:159], v[224:227], v[236:239], v[144:159]
    ds_read_b64_tr_b16 v[222:223], v19 offset:5120
    ds_read_b128 v[208:211], v20 offset:28672
    ds_read_b128 v[212:215], v20 offset:29696
    s_add_u32 s42, s80, 215040
    v_mfma_f32_32x32x16_bf16 v[160:175], v[228:231], v[232:235], v[160:175]
    buffer_load_dwordx4 v29, s[52:55], s42 offen lds
    v_mfma_f32_32x32x16_bf16 v[176:191], v[228:231], v[236:239], v[176:191]
    buffer_load_dwordx4 v30, s[52:55], s42 offen offset:1024 lds
    v_mfma_f32_32x32x16_bf16 v[128:143], v[192:195], v[200:203], v[128:143]
    s_waitcnt vmcnt(8) lgkmcnt(0)
    s_mov_b32 m0, s14
    ds_read_b64_tr_b16 v[232:233], v18 offset:6144
    ds_read_b64_tr_b16 v[234:235], v18 offset:7168
    ds_read_b64_tr_b16 v[236:237], v19 offset:6144
    v_mfma_f32_32x32x16_bf16 v[144:159], v[192:195], v[204:207], v[144:159]
    ds_read_b64_tr_b16 v[238:239], v19 offset:7168
    ds_read_b128 v[224:227], v20 offset:30720
    ds_read_b128 v[228:231], v20 offset:31744
    s_add_u32 s42, s79, 0
    s_nop 0
    v_mfma_f32_32x32x16_bf16 v[160:175], v[196:199], v[200:203], v[160:175]
    buffer_load_dwordx4 v31, s[56:59], s42 offen lds
    v_mfma_f32_32x32x16_bf16 v[176:191], v[196:199], v[204:207], v[176:191]
    buffer_load_dwordx4 v11, s[56:59], s42 offen offset:1024 lds
    v_mfma_f32_32x32x16_bf16 v[128:143], v[208:211], v[216:219], v[128:143]
    s_waitcnt vmcnt(8) lgkmcnt(0)
    s_mov_b32 m0, s15
    ds_read_b64_tr_b16 v[200:201], v18 offset:8192
    ds_read_b64_tr_b16 v[202:203], v18 offset:9216
    ds_read_b64_tr_b16 v[204:205], v19 offset:8192
    v_mfma_f32_32x32x16_bf16 v[144:159], v[208:211], v[220:223], v[144:159]
    ds_read_b64_tr_b16 v[206:207], v19 offset:9216
    ds_read_b128 v[192:195], v20 offset:36864
    ds_read_b128 v[196:199], v20 offset:37888
    s_add_u32 s42, s79, 14336
    v_mfma_f32_32x32x16_bf16 v[160:175], v[212:215], v[216:219], v[160:175]
    buffer_load_dwordx4 v31, s[56:59], s42 offen lds
    v_mfma_f32_32x32x16_bf16 v[176:191], v[212:215], v[220:223], v[176:191]
    buffer_load_dwordx4 v11, s[56:59], s42 offen offset:1024 lds
    v_mfma_f32_32x32x16_bf16 v[128:143], v[224:227], v[232:235], v[128:143]
    s_waitcnt vmcnt(8) lgkmcnt(0)
    s_mov_b32 m0, s16
    ds_read_b64_tr_b16 v[216:217], v18 offset:10240
    ds_read_b64_tr_b16 v[218:219], v18 offset:11264
    ds_read_b64_tr_b16 v[220:221], v19 offset:10240
    v_mfma_f32_32x32x16_bf16 v[144:159], v[224:227], v[236:239], v[144:159]
    ds_read_b64_tr_b16 v[222:223], v19 offset:11264
    ds_read_b128 v[208:211], v20 offset:38912
    ds_read_b128 v[212:215], v20 offset:39936
    s_add_u32 s42, s79, 28672
    v_mfma_f32_32x32x16_bf16 v[160:175], v[228:231], v[232:235], v[160:175]
    buffer_load_dwordx4 v31, s[56:59], s42 offen lds
    v_mfma_f32_32x32x16_bf16 v[176:191], v[228:231], v[236:239], v[176:191]
    buffer_load_dwordx4 v11, s[56:59], s42 offen offset:1024 lds
    v_mfma_f32_32x32x16_bf16 v[128:143], v[192:195], v[200:203], v[128:143]
    s_waitcnt vmcnt(8) lgkmcnt(0)
    s_mov_b32 m0, s17
    ds_read_b64_tr_b16 v[232:233], v18 offset:0
    ds_read_b64_tr_b16 v[234:235], v18 offset:1024
    ds_read_b64_tr_b16 v[236:237], v19 offset:0
    v_mfma_f32_32x32x16_bf16 v[144:159], v[192:195], v[204:207], v[144:159]
    ds_read_b64_tr_b16 v[238:239], v19 offset:1024
    ds_read_b128 v[224:227], v20 offset:40960
    ds_read_b128 v[228:231], v20 offset:41984
    s_add_u32 s42, s79, 43008
    v_mfma_f32_32x32x16_bf16 v[160:175], v[196:199], v[200:203], v[160:175]
    buffer_load_dwordx4 v31, s[56:59], s42 offen lds
    v_mfma_f32_32x32x16_bf16 v[176:191], v[196:199], v[204:207], v[176:191]
    buffer_load_dwordx4 v11, s[56:59], s42 offen offset:1024 lds
    v_mfma_f32_32x32x16_bf16 v[128:143], v[208:211], v[216:219], v[128:143]
    s_waitcnt vmcnt(8) lgkmcnt(0)
    s_mov_b32 m0, s12
    ds_read_b64_tr_b16 v[200:201], v18 offset:2048
    ds_read_b64_tr_b16 v[202:203], v18 offset:3072
    ds_read_b64_tr_b16 v[204:205], v19 offset:2048
    v_mfma_f32_32x32x16_bf16 v[144:159], v[208:211], v[220:223], v[144:159]
    ds_read_b64_tr_b16 v[206:207], v19 offset:3072
    ds_read_b128 v[192:195], v20 offset:43008
    ds_read_b128 v[196:199], v20 offset:44032
    s_add_u32 s42, s79, 0
    s_nop 0
    v_mfma_f32_32x32x16_bf16 v[160:175], v[212:215], v[216:219], v[160:175]
    buffer_load_dwordx4 v31, s[60:63], s42 offen lds
    v_mfma_f32_32x32x16_bf16 v[176:191], v[212:215], v[220:223], v[176:191]
    buffer_load_dwordx4 v11, s[60:63], s42 offen offset:1024 lds
    s_waitcnt lgkmcnt(0)
    v_mov_b32 v2, 158224
K1_SPIN4:
    ds_read_b32 v3, v2
    s_waitcnt lgkmcnt(0)
    v_readfirstlane_b32 s42, v3
    s_nop 2
    s_cmp_ge_u32 s42, 4
    s_cbranch_scc0 K1_SPIN4_S
    s_setprio 3
    v_mfma_f32_32x32x16_bf16 v[128:143], v[224:227], v[232:235], v[128:143]
    s_waitcnt vmcnt(6)
    ds_read_b64_tr_b16 v[208:209], v21 offset:0
    ds_read_b64_tr_b16 v[210:211], v21 offset:512
    ds_read_b64_tr_b16 v[212:213], v22 offset:0
    ds_read_b64_tr_b16 v[214:215], v22 offset:512
    v_mfma_f32_32x32x16_bf16 v[144:159], v[224:227], v[236:239], v[144:159]
    ds_read_b128 v[64:67], v23 offset:4096
    ds_read_b128 v[72:75], v24 offset:4096
    ds_read_b128 v[80:83], v25 offset:4096
    ds_read_b128 v[88:91], v26 offset:4096
    s_mov_b32 m0, s13
    s_nop 0
    s_add_u32 s42, s79, 14336
    v_mfma_f32_32x32x16_bf16 v[160:175], v[228:231], v[232:235], v[160:175]
    buffer_load_dwordx4 v31, s[60:63], s42 offen lds
    v_mfma_f32_32x32x16_bf16 v[176:191], v[228:231], v[236:239], v[176:191]
    buffer_load_dwordx4 v11, s[60:63], s42 offen offset:1024 lds
    v_mfma_f32_32x32x16_bf16 v[128:143], v[192:195], v[200:203], v[128:143]
    s_waitcnt lgkmcnt(4)
    s_waitcnt vmcnt(4)
    ds_read_b64_tr_b16 v[224:225], v21 offset:12288
    ds_read_b64_tr_b16 v[226:227], v21 offset:12800
    ds_read_b64_tr_b16 v[228:229], v22 offset:12288
    ds_read_b64_tr_b16 v[230:231], v22 offset:12800
    v_mfma_f32_32x32x16_bf16 v[144:159], v[192:195], v[204:207], v[144:159]
    ds_read_b128 v[68:71], v23 offset:8192
    ds_read_b128 v[76:79], v24 offset:8192
    ds_read_b128 v[84:87], v25 offset:8192
    ds_read_b128 v[92:95], v26 offset:8192
    s_waitcnt lgkmcnt(8)
    s_mov_b32 m0, s14
    s_add_u32 s42, s79, 28672
    v_mfma_f32_32x32x16_bf16 v[160:175], v[196:199], v[200:203], v[160:175]
    buffer_load_dwordx4 v31, s[60:63], s42 offen lds
    v_mfma_f32_32x32x16_bf16 v[176:191], v[196:199], v[204:207], v[176:191]
    buffer_load_dwordx4 v11, s[60:63], s42 offen offset:1024 lds
    s_mov_b32 m0, s15
    s_nop 0
    s_add_u32 s42, s79, 43008
    buffer_load_dwordx4 v31, s[60:63], s42 offen lds
    buffer_load_dwordx4 v11, s[60:63], s42 offen offset:1024 lds
    s_setprio 1
    s_waitcnt lgkmcnt(0)
    v_mfma_f32_32x32x16_bf16 v[128:143], v[208:211], v[64:67], v[128:143]
    ds_read_b64_tr_b16 v[192:193], v21 offset:24576
    ds_read_b64_tr_b16 v[194:195], v21 offset:25088
    v_mfma_f32_32x32x16_bf16 v[144:159], v[208:211], v[68:71], v[144:159]
    ds_read_b64_tr_b16 v[196:197], v22 offset:24576
    ds_read_b64_tr_b16 v[198:199], v22 offset:25088
    v_mfma_f32_32x32x16_bf16 v[160:175], v[212:215], v[64:67], v[160:175]
    v_mfma_f32_32x32x16_bf16 v[176:191], v[212:215], v[68:71], v[176:191]
    v_mfma_f32_32x32x16_bf16 v[128:143], v[224:227], v[72:75], v[128:143]
    s_waitcnt vmcnt(4)
    s_nop 0
    ds_read_b64_tr_b16 v[208:209], v21 offset:36864
    ds_read_b64_tr_b16 v[210:211], v21 offset:37376
    ds_read_b64_tr_b16 v[212:213], v22 offset:36864
    ds_read_b64_tr_b16 v[214:215], v22 offset:37376
    v_mfma_f32_32x32x16_bf16 v[144:159], v[224:227], v[76:79], v[144:159]
    ds_read_b128 v[96:99], v23 offset:0
    ds_read_b128 v[104:107], v24 offset:0
    ds_read_b128 v[112:115], v25 offset:0
    ds_read_b128 v[120:123], v26 offset:0
    v_mfma_f32_32x32x16_bf16 v[160:175], v[228:231], v[72:75], v[160:175]
    s_waitcnt lgkmcnt(8)
    s_nop 0
    v_mfma_f32_32x32x16_bf16 v[176:191], v[228:231], v[76:79], v[176:191]
    v_mfma_f32_32x32x16_bf16 v[128:143], v[192:195], v[80:83], v[128:143]
    ds_read_b64_tr_b16 v[224:225], v21 offset:2048
    ds_read_b64_tr_b16 v[226:227], v21 offset:2560
    v_mfma_f32_32x32x16_bf16 v[144:159], v[192:195], v[84:87], v[144:159]
    ds_read_b64_tr_b16 v[228:229], v22 offset:2048
    ds_read_b64_tr_b16 v[230:231], v22 offset:2560
    v_mfma_f32_32x32x16_bf16 v[160:175], v[196:199], v[80:83], v[160:175]
    s_waitcnt lgkmcnt(8)
    v_mfma_f32_32x32x16_bf16 v[176:191], v[196:199], v[84:87], v[176:191]
    v_mfma_f32_32x32x16_bf16 v[128:143], v[208:211], v[88:91], v[128:143]
    s_waitcnt lgkmcnt(4)
    s_waitcnt vmcnt(0)
    s_nop 0
    ds_read_b64_tr_b16 v[192:193], v21 offset:14336
    ds_read_b64_tr_b16 v[194:195], v21 offset:14848
    ds_read_b64_tr_b16 v[196:197], v22 offset:14336
    ds_read_b64_tr_b16 v[198:199], v22 offset:14848
    v_mfma_f32_32x32x16_bf16 v[144:159], v[208:211], v[92:95], v[144:159]
    ds_read_b128 v[100:103], v23 offset:4096
    ds_read_b128 v[108:111], v24 offset:4096
    ds_read_b128 v[116:119], v25 offset:4096
    ds_read_b128 v[124:127], v26 offset:4096
    v_mfma_f32_32x32x16_bf16 v[160:175], v[212:215], v[88:91], v[160:175]
    s_waitcnt lgkmcnt(8)
    v_mfma_f32_32x32x16_bf16 v[176:191], v[212:215], v[92:95], v[176:191]
    s_waitcnt lgkmcnt(0)
    v_mfma_f32_32x32x16_bf16 v[128:143], v[224:227], v[96:99], v[128:143]
    ds_read_b64_tr_b16 v[208:209], v21 offset:26624
    ds_read_b64_tr_b16 v[210:211], v21 offset:27136
    v_mfma_f32_32x32x16_bf16 v[144:159], v[224:227], v[100:103], v[144:159]
    ds_read_b64_tr_b16 v[212:213], v22 offset:26624
    ds_read_b64_tr_b16 v[214:215], v22 offset:27136
    v_mfma_f32_32x32x16_bf16 v[160:175], v[228:231], v[96:99], v[160:175]
    v_mfma_f32_32x32x16_bf16 v[176:191], v[228:231], v[100:103], v[176:191]
    v_mfma_f32_32x32x16_bf16 v[128:143], v[192:195], v[104:107], v[128:143]
    ds_read_b64_tr_b16 v[224:225], v21 offset:38912
    ds_read_b64_tr_b16 v[226:227], v21 offset:39424
    v_mfma_f32_32x32x16_bf16 v[144:159], v[192:195], v[108:111], v[144:159]
    ds_read_b64_tr_b16 v[228:229], v22 offset:38912
    ds_read_b64_tr_b16 v[230:231], v22 offset:39424
    v_mfma_f32_32x32x16_bf16 v[160:175], v[196:199], v[104:107], v[160:175]
    s_waitcnt lgkmcnt(4)
    s_nop 0
    v_mfma_f32_32x32x16_bf16 v[176:191], v[196:199], v[108:111], v[176:191]
    v_mfma_f32_32x32x16_bf16 v[128:143], v[208:211], v[112:115], v[128:143]
    v_mfma_f32_32x32x16_bf16 v[144:159], v[208:211], v[116:119], v[144:159]
    v_mfma_f32_32x32x16_bf16 v[160:175], v[212:215], v[112:115], v[160:175]
    s_waitcnt lgkmcnt(0)
    s_nop 0
    v_mfma_f32_32x32x16_bf16 v[176:191], v[212:215], v[116:119], v[176:191]
    v_mfma_f32_32x32x16_bf16 v[128:143], v[224:227], v[120:123], v[128:143]
    v_mfma_f32_32x32x16_bf16 v[144:159], v[224:227], v[124:127], v[144:159]
    v_mfma_f32_32x32x16_bf16 v[160:175], v[228:231], v[120:123], v[160:175]
    v_mfma_f32_32x32x16_bf16 v[176:191], v[228:231], v[124:127], v[176:191]
    s_mul_i32 s42, s39, 7
    s_add_u32 s42, s42, s40
    s_mul_i32 s42, s42, 57344
    s_lshl_b32 s43, s38, 10
    s_add_u32 s42, s42, s43
    s_add_u32 s42, s42, 1048576
    v_lshlrev_b32 v2, 4, v1
    s_cmp_eq_u32 s40, s38
    s_cbranch_scc1 K1_OWN
    s_nop 0
    v_cvt_pk_bf16_f32 v32, v128, v129
    v_cvt_pk_bf16_f32 v33, v130, v131
    v_cvt_pk_bf16_f32 v34, v132, v133
    v_cvt_pk_bf16_f32 v35, v134, v135
    s_add_u32 s43, s42, 0
    s_nop 0
    buffer_store_dwordx4 v[32:35], v2, s[68:71], s43 offen sc1
    v_cvt_pk_bf16_f32 v36, v136, v137
    v_cvt_pk_bf16_f32 v37, v138, v139
    v_cvt_pk_bf16_f32 v38, v140, v141
    v_cvt_pk_bf16_f32 v39, v142, v143
    s_add_u32 s43, s42, 7168
    buffer_store_dwordx4 v[36:39], v2, s[68:71], s43 offen sc1
    v_cvt_pk_bf16_f32 v40, v144, v145
    v_cvt_pk_bf16_f32 v41, v146, v147
    v_cvt_pk_bf16_f32 v42, v148, v149
    v_cvt_pk_bf16_f32 v43, v150, v151
    s_add_u32 s43, s42, 14336
    buffer_store_dwordx4 v[40:43], v2, s[68:71], s43 offen sc1
    v_cvt_pk_bf16_f32 v44, v152, v153
    v_cvt_pk_bf16_f32 v45, v154, v155
    v_cvt_pk_bf16_f32 v46, v156, v157
    v_cvt_pk_bf16_f32 v47, v158, v159
    s_add_u32 s43, s42, 21504
    buffer_store_dwordx4 v[44:47], v2, s[68:71], s43 offen sc1
    v_cvt_pk_bf16_f32 v32, v160, v161
    v_cvt_pk_bf16_f32 v33, v162, v163
    v_cvt_pk_bf16_f32 v34, v164, v165
    v_cvt_pk_bf16_f32 v35, v166, v167
    s_add_u32 s43, s42, 28672
    buffer_store_dwordx4 v[32:35], v2, s[68:71], s43 offen sc1
    v_cvt_pk_bf16_f32 v36, v168, v169
    v_cvt_pk_bf16_f32 v37, v170, v171
    v_cvt_pk_bf16_f32 v38, v172, v173
    v_cvt_pk_bf16_f32 v39, v174, v175
    s_add_u32 s43, s42, 35840
    buffer_store_dwordx4 v[36:39], v2, s[68:71], s43 offen sc1
    v_cvt_pk_bf16_f32 v40, v176, v177
    v_cvt_pk_bf16_f32 v41, v178, v179
    v_cvt_pk_bf16_f32 v42, v180, v181
    v_cvt_pk_bf16_f32 v43, v182, v183
    s_add_u32 s43, s42, 43008
    buffer_store_dwordx4 v[40:43], v2, s[68:71], s43 offen sc1
    v_cvt_pk_bf16_f32 v44, v184, v185
    v_cvt_pk_bf16_f32 v45, v186, v187
    v_cvt_pk_bf16_f32 v46, v188, v189
    v_cvt_pk_bf16_f32 v47, v190, v191
    s_add_u32 s43, s42, 50176
    buffer_store_dwordx4 v[44:47], v2, s[68:71], s43 offen sc1
    v_and_b32 v3, 31, v1
    v_lshrrev_b32 v4, 5, v1
    s_lshr_b32 s42, s40, 2
    s_lshl_b32 s42, s42, 5
    s_and_b32 s43, s40, 1
    s_lshl_b32 s43, s43, 4
    s_add_u32 s42, s42, s43
    v_lshl_add_u32 v6, v4, 2, s42
    s_bfe_u32 s42, s40, 0x10001
    s_lshl_b32 s42, s42, 5
    s_lshl_b32 s43, s38, 6
    s_add_u32 s42, s42, s43
    v_add_u32 v5, s42, v3
    s_lshl_b32 s42, s39, 6
    v_add_u32_e64 v7, s42, v6
    v_mul_u32_u24 v8, 896, v7
    v_lshl_add_u32 v8, v5, 1, v8
    v_add_u32 v9, 7168, v8
    v_lshlrev_b32_e64 v10, 1, v5
    v_mul_u32_u24 v12, 1792, v7
    v_lshl_add_u32 v12, v5, 2, v12
    v_add_u32 v13, 14336, v12
    v_add_u32 v14, 3584, v12
    v_add_u32 v15, 3584, v13
    v_lshlrev_b32_e64 v6, 2, v6
    v_add_u32 v6, 155648, v6
    s_mov_b32 s44, s4
    s_mov_b32 s45, s5
    s_mov_b32 s46, 1835008
    s_mov_b32 s47, 0x20000
    s_mov_b32 s48, s32
    s_mov_b32 s49, s33
    s_mov_b32 s50, 3670016
    s_mov_b32 s51, 0x20000
    buffer_load_ushort v16, v8, s[44:47], 0 offen offset:0
    buffer_load_ushort v17, v8, s[44:47], 0 offen offset:896
    buffer_load_ushort v18, v8, s[44:47], 0 offen offset:1792
    buffer_load_ushort v19, v8, s[44:47], 0 offen offset:2688
    buffer_load_ushort v20, v9, s[44:47], 0 offen offset:0
    buffer_load_ushort v21, v9, s[44:47], 0 offen offset:896
    buffer_load_ushort v22, v9, s[44:47], 0 offen offset:1792
    buffer_load_ushort v23, v9, s[44:47], 0 offen offset:2688
    global_load_ushort v24, v10, s[20:21]
    global_load_ushort v25, v10, s[30:31]
    s_waitcnt vmcnt(10)
    s_mul_i32 s42, s39, 7
    s_add_u32 s42, s42, s40
    s_lshl_b32 s42, s42, 7
    s_lshl_b32 s43, s38, 2
    s_add_u32 s42, s42, s43
    s_add_u32 s42, s42, 786432
    v_mov_b32 v2, 1
    v_mov_b32 v3, 0
    s_mov_b64 exec, 1
    buffer_store_dword v2, v3, s[68:71], s42 offen sc1
    s_mov_b64 exec, -1
K1_SIGD:
    v_mov_b32 v2, 158240
    v_mov_b32 v3, 1
    s_mov_b64 exec, 1
    ds_add_u32 v2, v3
    s_mov_b64 exec, -1
K1_RED:
    s_nop 0
    ds_read_b128 v[64:67], v6 offset:256
    ds_read_b128 v[68:71], v6 offset:288
    ds_read_b128 v[72:75], v6 offset:2816
    ds_read_b128 v[76:79], v6 offset:2848
    s_mul_i32 s42, s39, 7
    s_add_u32 s42, s42, s38
    s_lshl_b32 s42, s42, 3
    s_add_u32 s42, s42, s40
    s_mul_i32 s42, s42, 7168
    s_add_u32 s42, s42, 1048576
    v_lshlrev_b32 v7, 4, v1
    s_waitcnt lgkmcnt(0)
    s_mul_i32 s42, s39, 7
    s_add_u32 s42, s42, s38
    s_lshl_b32 s42, s42, 3
    s_add_u32 s42, s42, s40
    s_mul_i32 s42, s42, 7168
    s_add_u32 s82, s42, 1048576
    s_mul_i32 s42, s38, 12288
    s_add_u32 s43, s42, 106496
    s_sub_u32 s42, s42, 49152
    s_cmp_lt_u32 s38, 4
    s_cselect_b32 s42, s43, s42
    s_lshl_b32 s43, s40, 10
    s_add_u32 s42, s42, s43
    v_add_u32_e64 v30, s42, v7
    v_mov_b32 v2, 158244
K1_SPIN5:
    ds_read_b32 v3, v2
    s_waitcnt lgkmcnt(0)
    v_readfirstlane_b32 s42, v3
    s_nop 2
    s_cmp_ge_u32 s42, 1
    s_cbranch_scc0 K1_SPIN5_S
    s_cmp_ge_u32 0, s38
    s_cselect_b32 s42, 1, 0
    s_lshl_b32 s42, s42, 10
    s_add_u32 s42, s42, s82
    buffer_load_dwordx4 v[32:35], v7, s[68:71], s42 offen sc1
    s_cmp_ge_u32 1, s38
    s_cselect_b32 s42, 2, 1
    s_lshl_b32 s42, s42, 10
    s_add_u32 s42, s42, s82
    buffer_load_dwordx4 v[36:39], v7, s[68:71], s42 offen sc1
    s_cmp_ge_u32 2, s38
    s_cselect_b32 s42, 3, 2
    s_lshl_b32 s42, s42, 10
    s_add_u32 s42, s42, s82
    buffer_load_dwordx4 v[40:43], v7, s[68:71], s42 offen sc1
    s_cmp_ge_u32 3, s38
    s_cselect_b32 s42, 4, 3
    s_lshl_b32 s42, s42, 10
    s_add_u32 s42, s42, s82
    buffer_load_dwordx4 v[44:47], v7, s[68:71], s42 offen sc1
    s_cmp_ge_u32 4, s38
    s_cselect_b32 s42, 5, 4
    s_lshl_b32 s42, s42, 10
    s_add_u32 s42, s42, s82
    buffer_load_dwordx4 v[48:51], v7, s[68:71], s42 offen sc1
    s_cmp_ge_u32 5, s38
    s_cselect_b32 s42, 6, 5
    s_lshl_b32 s42, s42, 10
    s_add_u32 s42, s42, s82
    buffer_load_dwordx4 v[52:55], v7, s[68:71], s42 offen sc1
    ds_read_b128 v[56:59], v30
    s_waitcnt vmcnt(6)
    v_lshlrev_b32 v24, 16, v24
    v_lshlrev_b32 v25, 16, v25
    v_lshlrev_b32 v26, 16, v16
    v_sub_f32 v27, v26, v64
    v_add_f32 v80, v25, v26
    v_mul_f32 v27, v27, v72
    v_fmac_f32 v80, v27, v24
    v_lshlrev_b32 v26, 16, v17
    v_sub_f32 v27, v26, v65
    v_add_f32 v81, v25, v26
    v_mul_f32 v27, v27, v73
    v_fmac_f32 v81, v27, v24
    v_lshlrev_b32 v26, 16, v18
    v_sub_f32 v27, v26, v66
    v_add_f32 v82, v25, v26
    v_mul_f32 v27, v27, v74
    v_fmac_f32 v82, v27, v24
    v_lshlrev_b32 v26, 16, v19
    v_sub_f32 v27, v26, v67
    v_add_f32 v83, v25, v26
    v_mul_f32 v27, v27, v75
    v_fmac_f32 v83, v27, v24
    v_lshlrev_b32 v26, 16, v20
    v_sub_f32 v27, v26, v68
    v_add_f32 v84, v25, v26
    v_mul_f32 v27, v27, v76
    v_fmac_f32 v84, v27, v24
    v_lshlrev_b32 v26, 16, v21
    v_sub_f32 v27, v26, v69
    v_add_f32 v85, v25, v26
    v_mul_f32 v27, v27, v77
    v_fmac_f32 v85, v27, v24
    v_lshlrev_b32 v26, 16, v22
    v_sub_f32 v27, v26, v70
    v_add_f32 v86, v25, v26
    v_mul_f32 v27, v27, v78
    v_fmac_f32 v86, v27, v24
    v_lshlrev_b32 v26, 16, v23
    v_sub_f32 v27, v26, v71
    v_add_f32 v87, v25, v26
    v_mul_f32 v27, v27, v79
    v_fmac_f32 v87, v27, v24
    s_waitcnt lgkmcnt(0)
    v_lshlrev_b32 v28, 16, v56
    v_and_b32 v29, 0xffff0000, v56
    v_add_f32 v80, v80, v28
    v_add_f32 v81, v81, v29
    v_lshlrev_b32_e64 v28, 16, v57
    v_and_b32 v29, 0xffff0000, v57
    v_add_f32 v82, v82, v28
    v_add_f32 v83, v83, v29
    v_lshlrev_b32_e64 v28, 16, v58
    v_and_b32 v29, 0xffff0000, v58
    v_add_f32 v84, v84, v28
    v_add_f32 v85, v85, v29
    v_lshlrev_b32_e64 v28, 16, v59
    v_and_b32 v29, 0xffff0000, v59
    v_add_f32 v86, v86, v28
    v_add_f32 v87, v87, v29
    s_waitcnt vmcnt(5)
    v_lshlrev_b32 v28, 16, v32
    v_and_b32 v29, 0xffff0000, v32
    v_add_f32 v80, v80, v28
    v_add_f32 v81, v81, v29
    v_lshlrev_b32_e64 v28, 16, v33
    v_and_b32 v29, 0xffff0000, v33
    v_add_f32 v82, v82, v28
    v_add_f32 v83, v83, v29
    v_lshlrev_b32_e64 v28, 16, v34
    v_and_b32 v29, 0xffff0000, v34
    v_add_f32 v84, v84, v28
    v_add_f32 v85, v85, v29
    v_lshlrev_b32_e64 v28, 16, v35
    v_and_b32 v29, 0xffff0000, v35
    v_add_f32 v86, v86, v28
    v_add_f32 v87, v87, v29
    s_waitcnt vmcnt(4)
    v_lshlrev_b32 v28, 16, v36
    v_and_b32 v29, 0xffff0000, v36
    v_add_f32 v80, v80, v28
    v_add_f32 v81, v81, v29
    v_lshlrev_b32_e64 v28, 16, v37
    v_and_b32 v29, 0xffff0000, v37
    v_add_f32 v82, v82, v28
    v_add_f32 v83, v83, v29
    v_lshlrev_b32_e64 v28, 16, v38
    v_and_b32 v29, 0xffff0000, v38
    v_add_f32 v84, v84, v28
    v_add_f32 v85, v85, v29
    v_lshlrev_b32_e64 v28, 16, v39
    v_and_b32 v29, 0xffff0000, v39
    v_add_f32 v86, v86, v28
    v_add_f32 v87, v87, v29
    s_waitcnt vmcnt(3)
    v_lshlrev_b32 v28, 16, v40
    v_and_b32 v29, 0xffff0000, v40
    v_add_f32 v80, v80, v28
    v_add_f32 v81, v81, v29
    v_lshlrev_b32_e64 v28, 16, v41
    v_and_b32 v29, 0xffff0000, v41
    v_add_f32 v82, v82, v28
    v_add_f32 v83, v83, v29
    v_lshlrev_b32_e64 v28, 16, v42
    v_and_b32 v29, 0xffff0000, v42
    v_add_f32 v84, v84, v28
    v_add_f32 v85, v85, v29
    v_lshlrev_b32_e64 v28, 16, v43
    v_and_b32 v29, 0xffff0000, v43
    v_add_f32 v86, v86, v28
    v_add_f32 v87, v87, v29
    s_waitcnt vmcnt(2)
    v_lshlrev_b32 v28, 16, v44
    v_and_b32 v29, 0xffff0000, v44
    v_add_f32 v80, v80, v28
    v_add_f32 v81, v81, v29
    v_lshlrev_b32_e64 v28, 16, v45
    v_and_b32 v29, 0xffff0000, v45
    v_add_f32 v82, v82, v28
    v_add_f32 v83, v83, v29
    v_lshlrev_b32_e64 v28, 16, v46
    v_and_b32 v29, 0xffff0000, v46
    v_add_f32 v84, v84, v28
    v_add_f32 v85, v85, v29
    v_lshlrev_b32_e64 v28, 16, v47
    v_and_b32 v29, 0xffff0000, v47
    v_add_f32 v86, v86, v28
    v_add_f32 v87, v87, v29
    s_waitcnt vmcnt(1)
    v_lshlrev_b32 v28, 16, v48
    v_and_b32 v29, 0xffff0000, v48
    v_add_f32 v80, v80, v28
    v_add_f32 v81, v81, v29
    v_lshlrev_b32_e64 v28, 16, v49
    v_and_b32 v29, 0xffff0000, v49
    v_add_f32 v82, v82, v28
    v_add_f32 v83, v83, v29
    v_lshlrev_b32_e64 v28, 16, v50
    v_and_b32 v29, 0xffff0000, v50
    v_add_f32 v84, v84, v28
    v_add_f32 v85, v85, v29
    v_lshlrev_b32_e64 v28, 16, v51
    v_and_b32 v29, 0xffff0000, v51
    v_add_f32 v86, v86, v28
    v_add_f32 v87, v87, v29
    s_waitcnt vmcnt(0)
    v_lshlrev_b32 v28, 16, v52
    v_and_b32 v29, 0xffff0000, v52
    v_add_f32 v80, v80, v28
    v_add_f32 v81, v81, v29
    buffer_store_dword v80, v12, s[48:51], 0 offen offset:0
    buffer_store_dword v81, v12, s[48:51], 0 offen offset:1792
    v_lshlrev_b32_e64 v28, 16, v53
    v_and_b32 v29, 0xffff0000, v53
    v_add_f32 v82, v82, v28
    v_add_f32 v83, v83, v29
    buffer_store_dword v82, v12, s[48:51], 0 offen offset:3584
    buffer_store_dword v83, v14, s[48:51], 0 offen offset:1792
    v_lshlrev_b32_e64 v28, 16, v54
    v_and_b32 v29, 0xffff0000, v54
    v_add_f32 v84, v84, v28
    v_add_f32 v85, v85, v29
    buffer_store_dword v84, v13, s[48:51], 0 offen offset:0
    buffer_store_dword v85, v13, s[48:51], 0 offen offset:1792
    v_lshlrev_b32_e64 v28, 16, v55
    v_and_b32 v29, 0xffff0000, v55
    v_add_f32 v86, v86, v28
    v_add_f32 v87, v87, v29
    buffer_store_dword v86, v13, s[48:51], 0 offen offset:3584
    buffer_store_dword v87, v15, s[48:51], 0 offen offset:1792
    s_endpgm
K1_G1_PRE:
    s_mov_b32 s48, s10
    s_mov_b32 s49, s11
    s_mov_b32 s50, 401408
    s_mov_b32 s51, 0x20000
    s_mov_b32 s64, s12
    s_mov_b32 s65, s13
    s_mov_b32 s66, 401408
    s_mov_b32 s67, 0x20000
    s_sub_u32 s82, s40, 4
    s_mul_i32 s41, s82, 12288
    s_add_u32 s78, s41, 0
    s_add_u32 s41, s41, 57344
    s_mul_i32 s76, s88, 896
    s_mov_b32 s89, 0
    s_mov_b32 s90, 128
    v_mov_b32 v27, v31
    v_mov_b32 v28, v11
    s_mov_b32 s91, s76
    v_lshrrev_b32 v2, 5, v1
    v_bfe_u32 v3, v1, 2, 2
    v_and_b32_e64 v4, 3, v1
    v_bfe_u32 v5, v1, 4, 1
    v_lshlrev_b32 v6, 1, v5
    v_lshrrev_b32 v7, 1, v4
    v_or_b32 v6, v6, v7
    v_lshrrev_b32 v7, 1, v3
    v_lshlrev_b32 v7, 2, v7
    v_xor_b32 v6, v6, v7
    v_lshlrev_b32 v6, 4, v6
    v_and_b32 v7, 1, v4
    v_lshl_add_u32 v6, v7, 3, v6
    v_lshl_add_u32 v7, v2, 3, v3
    v_lshl_add_u32 v8, v7, 7, v6
    v_lshl_add_u32 v7, v2, 2, v3
    v_lshl_add_u32 v9, v7, 7, v6
    v_add_u32 v18, s78, v9
    v_xor_b32 v19, 64, v18
    v_add_u32 v21, 65536, v8
    v_xor_b32 v22, 64, v21
    v_lshlrev_b32 v20, 4, v1
    v_add_u32 v20, 57344, v20
    v_and_b32 v3, 31, v1
    v_lshrrev_b32 v2, 5, v1
    v_bfe_u32 v4, v3, 1, 3
    v_xor_b32 v4, v4, v2
    v_lshlrev_b32 v4, 4, v4
    v_lshl_add_u32 v4, v3, 7, v4
    v_add_u32 v23, s78, v4
    v_xor_b32 v24, 32, v23
    v_xor_b32_e64 v25, 64, v23
    v_xor_b32 v26, 96, v23
    v_and_b32 v2, 15, v1
    v_lshrrev_b32 v3, 4, v1
    v_bfe_u32 v4, v2, 1, 3
    v_xor_b32 v4, v4, v3
    v_lshlrev_b32 v4, 4, v4
    v_lshl_add_u32 v4, v2, 7, v4
    v_add_u32 v12, s41, v4
    v_xor_b32 v13, 64, v12
    v_lshrrev_b32 v4, 2, v2
    v_and_b32 v5, 3, v2
    v_lshl_add_u32 v6, v4, 4, v5
    v_mul_u32_u24 v6, 896, v6
    v_and_b32 v7, 1, v4
    v_mul_u32_u24 v7, 3, v7
    v_lshrrev_b32 v8, 1, v4
    v_xor_b32 v7, v7, v8
    v_lshlrev_b32 v7, 1, v7
    v_lshrrev_b32 v8, 1, v5
    v_xor_b32 v7, v7, v8
    v_xor_b32 v7, v7, v3
    v_xor_b32_e64 v8, 0, v7
    v_lshl_add_u32 v14, v8, 4, v6
    v_xor_b32_e64 v8, 2, v7
    v_lshl_add_u32 v15, v8, 4, v6
    v_xor_b32_e64 v8, 4, v7
    v_lshl_add_u32 v16, v8, 4, v6
    v_xor_b32_e64 v8, 6, v7
    v_lshl_add_u32 v17, v8, 4, v6
    s_lshl_b32 s42, s82, 9
    s_add_u32 s42, s42, 156160
    v_lshlrev_b32 v6, 5, v2
    v_add_u32_e64 v244, s42, v6
    v_lshl_add_u32 v245, v3, 3, v244
    v_lshlrev_b32_e64 v4, 1, v3
    v_bfe_u32 v5, v2, 1, 1
    v_lshlrev_b32 v5, 2, v5
    v_xor_b32 v4, v4, v5
    v_lshlrev_b32_e64 v4, 4, v4
    v_lshl_add_u32 v4, v2, 7, v4
    v_add_u32 v246, s41, v4
    v_lshlrev_b32 v247, 3, v2
    s_lshl_b32 s42, s38, 5
    s_add_u32 s42, s42, s39
    s_lshl_b32 s42, s42, 10
    s_lshl_b32 s43, s82, 8
    s_add_u32 s42, s42, s43
    s_add_u32 s42, s42, 262144
    v_lshlrev_b32 v250, 4, v2
    v_add_u32 v250, s42, v250
    s_barrier
    s_waitcnt vmcnt(0)
    s_mul_i32 s42, s92, 8
    s_sub_u32 s43, s40, 4
    s_mul_i32 s43, s43, 2
    s_add_u32 s42, s42, s43
    s_and_b32 s43, s42, 63
    s_lshl_b32 s94, s38, 6
    s_add_u32 s43, s43, s94
    s_mul_i32 s43, s43, 896
    s_cmp_ge_u32 s42, 64
    s_cselect_b32 s94, s12, s10
    s_cselect_b32 s95, s13, s11
    s_add_u32 s94, s94, s43
    s_addc_u32 s95, s95, 0
    s_mov_b64 exec, 0x3fff
    global_load_dword v253, v249, s[94:95]
    s_mov_b64 exec, -1
    v_mov_b32 v2, 0
    v_mov_b32 v3, 0
    v_mov_b32 v4, 0
    v_mov_b32 v5, 0
    v_mov_b32 v60, 0x3f803f80
    v_dot2c_f32_bf16 v2, v60, v32
    v_dot2c_f32_bf16 v4, v32, v32
    v_dot2c_f32_bf16 v3, v60, v33
    v_dot2c_f32_bf16 v5, v33, v33
    v_dot2c_f32_bf16 v2, v60, v34
    v_dot2c_f32_bf16 v4, v34, v34
    v_dot2c_f32_bf16 v3, v60, v35
    v_dot2c_f32_bf16 v5, v35, v35
    v_dot2c_f32_bf16 v2, v60, v36
    v_dot2c_f32_bf16 v4, v36, v36
    v_dot2c_f32_bf16 v3, v60, v37
    v_dot2c_f32_bf16 v5, v37, v37
    v_dot2c_f32_bf16 v2, v60, v38
    v_dot2c_f32_bf16 v4, v38, v38
    v_dot2c_f32_bf16 v3, v60, v39
    v_dot2c_f32_bf16 v5, v39, v39
    v_dot2c_f32_bf16 v2, v60, v40
    v_dot2c_f32_bf16 v4, v40, v40
    v_dot2c_f32_bf16 v3, v60, v41
    v_dot2c_f32_bf16 v5, v41, v41
    v_dot2c_f32_bf16 v2, v60, v42
    v_dot2c_f32_bf16 v4, v42, v42
    v_dot2c_f32_bf16 v3, v60, v43
    v_dot2c_f32_bf16 v5, v43, v43
    v_dot2c_f32_bf16 v2, v60, v44
    v_dot2c_f32_bf16 v4, v44, v44
    v_dot2c_f32_bf16 v3, v60, v45
    v_dot2c_f32_bf16 v5, v45, v45
    v_dot2c_f32_bf16 v2, v60, v46
    v_dot2c_f32_bf16 v4, v46, v46
    v_dot2c_f32_bf16 v3, v60, v47
    v_dot2c_f32_bf16 v5, v47, v47
    v_dot2c_f32_bf16 v2, v60, v48
    v_dot2c_f32_bf16 v4, v48, v48
    v_dot2c_f32_bf16 v3, v60, v49
    v_dot2c_f32_bf16 v5, v49, v49
    v_dot2c_f32_bf16 v2, v60, v50
    v_dot2c_f32_bf16 v4, v50, v50
    v_dot2c_f32_bf16 v3, v60, v51
    v_dot2c_f32_bf16 v5, v51, v51
    v_dot2c_f32_bf16 v2, v60, v52
    v_dot2c_f32_bf16 v4, v52, v52
    v_dot2c_f32_bf16 v3, v60, v53
    v_dot2c_f32_bf16 v5, v53, v53
    v_dot2c_f32_bf16 v2, v60, v54
    v_dot2c_f32_bf16 v4, v54, v54
    v_dot2c_f32_bf16 v3, v60, v55
    v_dot2c_f32_bf16 v5, v55, v55
    v_dot2c_f32_bf16 v2, v60, v56
    v_dot2c_f32_bf16 v4, v56, v56
    v_dot2c_f32_bf16 v3, v60, v57
    v_dot2c_f32_bf16 v5, v57, v57
    v_dot2c_f32_bf16 v2, v60, v58
    v_dot2c_f32_bf16 v4, v58, v58
    v_dot2c_f32_bf16 v3, v60, v59
    v_dot2c_f32_bf16 v5, v59, v59
    s_nop 1
    v_add_f32 v2, v2, v3
    v_lshlrev_b32 v128, 16, v32
    v_add_f32 v4, v4, v5
    v_and_b32 v129, 0xffff0000, v32
    v_add_f32_dpp v2, v2, v2 quad_perm:[1,0,3,2] row_mask:0xf bank_mask:0xf
    v_lshlrev_b32_e64 v130, 16, v33
    v_add_f32_dpp v4, v4, v4 quad_perm:[1,0,3,2] row_mask:0xf bank_mask:0xf
    v_and_b32 v131, 0xffff0000, v33
    v_add_f32_dpp v2, v2, v2 quad_perm:[2,3,0,1] row_mask:0xf bank_mask:0xf
    v_lshlrev_b32_e64 v132, 16, v34
    v_add_f32_dpp v4, v4, v4 quad_perm:[2,3,0,1] row_mask:0xf bank_mask:0xf
    v_and_b32 v133, 0xffff0000, v34
    v_add_f32_dpp v2, v2, v2 row_half_mirror row_mask:0xf bank_mask:0xf
    v_lshlrev_b32_e64 v134, 16, v35
    v_add_f32_dpp v4, v4, v4 row_half_mirror row_mask:0xf bank_mask:0xf
    v_and_b32 v135, 0xffff0000, v35
    v_mul_f32 v5, 0x3b124925, v2
    v_lshlrev_b32_e64 v136, 16, v36
    v_mul_f32 v4, 0x3b124925, v4
    v_and_b32 v137, 0xffff0000, v36
    v_fma_f32 v4, -v5, v5, v4
    v_lshlrev_b32 v138, 16, v37
    v_max_f32 v4, 0, v4
    v_and_b32 v139, 0xffff0000, v37
    v_add_f32 v6, 0x3727c5ac, v4
    v_lshlrev_b32 v140, 16, v38
    v_rsq_f32 v6, v6
    v_and_b32 v141, 0xffff0000, v38
    v_mul_f32 v7, v6, v6
    v_lshlrev_b32 v142, 16, v39
    v_mul_f32_e64 v7, v7, v4
    v_and_b32 v143, 0xffff0000, v39
    v_add_f32 v7, 0x3727c5ac, v7
    v_lshlrev_b32 v144, 16, v40
    v_rsq_f32 v9, v7
    v_and_b32 v145, 0xffff0000, v40
    v_mul_f32 v3, v6, v9
    v_lshlrev_b32 v146, 16, v41
    v_mul_f32_e64 v8, v7, v9
    v_and_b32 v147, 0xffff0000, v41
    v_mul_f32 v2, v5, v3
    v_lshlrev_b32 v148, 16, v42
    v_sub_f32_e64 v2, 0, v2
    v_and_b32 v149, 0xffff0000, v42
    v_lshlrev_b32_e64 v150, 16, v43
    v_and_b32 v151, 0xffff0000, v43
    v_lshlrev_b32_e64 v152, 16, v44
    v_and_b32 v153, 0xffff0000, v44
    v_lshlrev_b32_e64 v154, 16, v45
    v_and_b32 v155, 0xffff0000, v45
    v_lshlrev_b32_e64 v156, 16, v46
    v_and_b32 v157, 0xffff0000, v46
    v_lshlrev_b32_e64 v158, 16, v47
    v_and_b32 v159, 0xffff0000, v47
    v_lshlrev_b32_e64 v160, 16, v48
    v_and_b32 v161, 0xffff0000, v48
    v_lshlrev_b32_e64 v162, 16, v49
    v_and_b32 v163, 0xffff0000, v49
    v_lshlrev_b32_e64 v164, 16, v50
    v_and_b32 v165, 0xffff0000, v50
    v_lshlrev_b32_e64 v166, 16, v51
    v_and_b32 v167, 0xffff0000, v51
    v_lshlrev_b32_e64 v168, 16, v52
    v_and_b32 v169, 0xffff0000, v52
    v_lshlrev_b32_e64 v170, 16, v53
    v_and_b32 v171, 0xffff0000, v53
    v_lshlrev_b32_e64 v172, 16, v54
    v_and_b32 v173, 0xffff0000, v54
    v_lshlrev_b32_e64 v174, 16, v55
    v_and_b32 v175, 0xffff0000, v55
    v_lshlrev_b32_e64 v176, 16, v56
    v_and_b32 v177, 0xffff0000, v56
    v_lshlrev_b32_e64 v178, 16, v57
    v_and_b32 v179, 0xffff0000, v57
    v_lshlrev_b32_e64 v180, 16, v58
    v_and_b32 v181, 0xffff0000, v58
    v_lshlrev_b32_e64 v182, 16, v59
    v_and_b32 v183, 0xffff0000, v59
    v_mov_b32 v60, v3
    v_mov_b32 v61, v3
    v_mov_b32 v4, v2
    v_mov_b32 v63, v5
    v_mov_b32_e64 v5, v2
    v_pk_fma_f32 v[128:129], v[128:129], v[60:61], v[4:5]
    v_pk_fma_f32 v[130:131], v[130:131], v[60:61], v[4:5]
    v_pk_fma_f32 v[132:133], v[132:133], v[60:61], v[4:5]
    v_pk_fma_f32 v[134:135], v[134:135], v[60:61], v[4:5]
    v_cvt_pk_bf16_f32 v32, v128, v129
    v_cvt_pk_bf16_f32 v33, v130, v131
    v_cvt_pk_bf16_f32 v34, v132, v133
    v_cvt_pk_bf16_f32 v35, v134, v135
    ds_write_b128 v10, v[32:35] offset:0
    v_pk_fma_f32 v[136:137], v[136:137], v[60:61], v[4:5]
    v_pk_fma_f32 v[138:139], v[138:139], v[60:61], v[4:5]
    v_pk_fma_f32 v[140:141], v[140:141], v[60:61], v[4:5]
    v_pk_fma_f32 v[142:143], v[142:143], v[60:61], v[4:5]
    v_cvt_pk_bf16_f32 v36, v136, v137
    v_cvt_pk_bf16_f32 v37, v138, v139
    v_cvt_pk_bf16_f32 v38, v140, v141
    v_cvt_pk_bf16_f32 v39, v142, v143
    ds_write_b128 v10, v[36:39] offset:128
    v_pk_fma_f32 v[144:145], v[144:145], v[60:61], v[4:5]
    v_pk_fma_f32 v[146:147], v[146:147], v[60:61], v[4:5]
    v_pk_fma_f32 v[148:149], v[148:149], v[60:61], v[4:5]
    v_pk_fma_f32 v[150:151], v[150:151], v[60:61], v[4:5]
    v_cvt_pk_bf16_f32 v40, v144, v145
    v_cvt_pk_bf16_f32 v41, v146, v147
    v_cvt_pk_bf16_f32 v42, v148, v149
    v_cvt_pk_bf16_f32 v43, v150, v151
    ds_write_b128 v10, v[40:43] offset:256
    v_pk_fma_f32 v[152:153], v[152:153], v[60:61], v[4:5]
    v_pk_fma_f32 v[154:155], v[154:155], v[60:61], v[4:5]
    v_pk_fma_f32 v[156:157], v[156:157], v[60:61], v[4:5]
    v_pk_fma_f32 v[158:159], v[158:159], v[60:61], v[4:5]
    v_cvt_pk_bf16_f32 v44, v152, v153
    v_cvt_pk_bf16_f32 v45, v154, v155
    v_cvt_pk_bf16_f32 v46, v156, v157
    v_cvt_pk_bf16_f32 v47, v158, v159
    ds_write_b128 v10, v[44:47] offset:384
    v_pk_fma_f32 v[160:161], v[160:161], v[60:61], v[4:5]
    v_pk_fma_f32 v[162:163], v[162:163], v[60:61], v[4:5]
    v_pk_fma_f32 v[164:165], v[164:165], v[60:61], v[4:5]
    v_pk_fma_f32 v[166:167], v[166:167], v[60:61], v[4:5]
    v_cvt_pk_bf16_f32 v48, v160, v161
    v_cvt_pk_bf16_f32 v49, v162, v163
    v_cvt_pk_bf16_f32 v50, v164, v165
    v_cvt_pk_bf16_f32 v51, v166, v167
    ds_write_b128 v10, v[48:51] offset:512
    v_pk_fma_f32 v[168:169], v[168:169], v[60:61], v[4:5]
    v_pk_fma_f32 v[170:171], v[170:171], v[60:61], v[4:5]
    v_pk_fma_f32 v[172:173], v[172:173], v[60:61], v[4:5]
    v_pk_fma_f32 v[174:175], v[174:175], v[60:61], v[4:5]
    v_cvt_pk_bf16_f32 v52, v168, v169
    v_cvt_pk_bf16_f32 v53, v170, v171
    v_cvt_pk_bf16_f32 v54, v172, v173
    v_cvt_pk_bf16_f32 v55, v174, v175
    ds_write_b128 v10, v[52:55] offset:640
    v_pk_fma_f32 v[176:177], v[176:177], v[60:61], v[4:5]
    v_pk_fma_f32 v[178:179], v[178:179], v[60:61], v[4:5]
    v_pk_fma_f32 v[180:181], v[180:181], v[60:61], v[4:5]
    v_pk_fma_f32 v[182:183], v[182:183], v[60:61], v[4:5]
    v_cvt_pk_bf16_f32 v56, v176, v177
    v_cvt_pk_bf16_f32 v57, v178, v179
    v_cvt_pk_bf16_f32 v58, v180, v181
    v_cvt_pk_bf16_f32 v59, v182, v183
    ds_write_b128 v10, v[56:59] offset:768
    v_and_b32 v2, 7, v1
    v_cmp_eq_u32 vcc, 0, v2
    s_nop 2
    s_and_saveexec_b64 s[82:83], vcc
    v_add_u32 v2, 155648, v62
    ds_write_b32 v2, v8
    ds_write_b32 v2, v63 offset:256
    ds_write_b32 v2, v6 offset:2816
    s_mov_b64 exec, s[82:83]
    s_waitcnt lgkmcnt(0)
    s_add_u32 s6, s41, 0
    s_add_u32 s12, s78, 0
    s_add_u32 s7, s41, 2048
    s_add_u32 s13, s78, 2048
    s_add_u32 s8, s41, 4096
    s_add_u32 s14, s78, 4096
    s_add_u32 s9, s41, 6144
    s_add_u32 s15, s78, 6144
    s_add_u32 s10, s41, 8192
    s_add_u32 s16, s78, 8192
    s_add_u32 s11, s41, 10240
    s_add_u32 s17, s78, 10240
    s_add_u32 m0, s41, 0
    s_nop 0
    buffer_load_dwordx4 v27, s[48:51], s91 offen lds
    buffer_load_dwordx4 v28, s[48:51], s91 offen offset:1024 lds
    s_add_u32 s91, s91, s89
    s_add_u32 m0, s41, 2048
    s_nop 0
    buffer_load_dwordx4 v27, s[64:67], s91 offen lds
    buffer_load_dwordx4 v28, s[64:67], s91 offen offset:1024 lds
    s_add_u32 s91, s91, s90
    s_add_u32 m0, s41, 4096
    s_nop 0
    buffer_load_dwordx4 v27, s[48:51], s91 offen lds
    buffer_load_dwordx4 v28, s[48:51], s91 offen offset:1024 lds
    s_add_u32 s91, s91, s89
    s_add_u32 m0, s41, 6144
    s_nop 0
    buffer_load_dwordx4 v27, s[64:67], s91 offen lds
    buffer_load_dwordx4 v28, s[64:67], s91 offen offset:1024 lds
    s_add_u32 s91, s91, s90
    s_add_u32 m0, s41, 8192
    s_nop 0
    buffer_load_dwordx4 v27, s[48:51], s91 offen lds
    buffer_load_dwordx4 v28, s[48:51], s91 offen offset:1024 lds
    s_add_u32 s91, s91, s89
    s_add_u32 m0, s41, 10240
    s_nop 0
    buffer_load_dwordx4 v27, s[64:67], s91 offen lds
    buffer_load_dwordx4 v28, s[64:67], s91 offen offset:1024 lds
    s_add_u32 s91, s91, s90
    s_mov_b64 exec, 0xfffffff
    global_load_dword v252, v248, s[24:25]
    s_mov_b64 exec, -1
    v_mov_b32 v44, 0
    v_mov_b32 v45, 0
    v_mov_b32 v46, 0
    v_mov_b32 v47, 0
    s_mov_b64 exec, 0xffff
    buffer_store_dwordx4 v[44:47], v250, s[68:71], 0 offen sc1
    s_mov_b64 exec, -1
    v_lshlrev_b32 v249, 5, v1
    s_cmp_eq_u32 s40, 4
    s_cbranch_scc0 K1_NORDY
    s_mov_b64 exec, 0x7f
    buffer_load_dword v251, v249, s[72:75], 0 offen sc1
    s_mov_b64 exec, -1
K1_NORDY:
    v_lshlrev_b32 v107, 16, v104
    v_lshlrev_b32 v108, 16, v105
    v_lshlrev_b32 v106, 16, v106
    v_mul_f32 v106, 0x3fb8aa3b, v106
    v_exp_f32 v106, v106
    s_nop 0
    v_cvt_pk_bf16_f32 v106, v106, v106
    v_lshlrev_b32 v106, 16, v106
    v_mul_f32 v109, v106, v107
    v_mul_f32_e64 v110, v106, v108
    v_mul_f32 v109, 0x3fb8aa3b, v109
    v_mul_f32 v110, 0x3e22f983, v110
    v_exp_f32 v109, v109
    v_rndne_f32 v111, v110
    v_sub_f32 v110, v110, v111
    v_cos_f32 v111, v110
    v_sin_f32 v112, v110
    v_mul_f32 v113, v107, v107
    v_fmac_f32 v113, v108, v108
    v_mul_f32 v104, v109, v111
    v_mul_f32 v105, v109, v112
    v_rcp_f32 v110, v113
    v_add_f32 v109, -1.0, v104
    v_mul_f32 v111, v109, v107
    v_mul_f32 v112, v105, v107
    v_fmac_f32_e64 v111, v105, v108
    v_fma_f32 v112, -v109, v108, v112
    v_add_f32 v110, v110, v110
    v_mul_f32 v116, v111, v110
    v_mul_f32 v117, v112, v110
    v_mul_f32 v118, v104, v104
    v_mul_f32_e64 v119, v104, v105
    v_fma_f32 v118, -v105, v105, v118
    v_add_f32 v119, v119, v119
    v_mul_f32 v120, v118, v118
    v_mul_f32_e64 v121, v118, v119
    v_fma_f32 v120, -v119, v119, v120
    v_add_f32 v121, v121, v121
    v_mul_f32 v118, v120, v120
    v_mul_f32_e64 v119, v120, v121
    v_fma_f32 v118, -v121, v121, v118
    v_add_f32 v119, v119, v119
    v_mul_f32 v106, v118, v118
    v_mul_f32_e64 v107, v118, v119
    v_fma_f32 v106, -v119, v119, v106
    v_add_f32 v107, v107, v107
    v_mul_f32 v118, v106, v106
    v_mul_f32_e64 v119, v106, v107
    v_fma_f32 v118, -v107, v107, v118
    v_add_f32 v119, v119, v119
    v_mul_f32 v120, v118, v106
    v_mul_f32_e64 v121, v118, v107
    v_fma_f32 v120, -v119, v107, v120
    v_fmac_f32 v121, v119, v106
    v_lshrrev_b32 v2, 4, v1
    v_mov_b32 v108, 1.0
    v_mov_b32 v109, 0
    v_cmp_eq_u32 vcc, 1, v2
    s_nop 1
    v_cndmask_b32 v108, v108, v106, vcc
    v_cndmask_b32 v109, v109, v107, vcc
    v_cmp_eq_u32 vcc, 2, v2
    s_nop 1
    v_cndmask_b32 v108, v108, v118, vcc
    v_cndmask_b32 v109, v109, v119, vcc
    v_cmp_eq_u32 vcc, 3, v2
    s_nop 1
    v_cndmask_b32 v108, v108, v120, vcc
    v_cndmask_b32 v109, v109, v121, vcc
    s_barrier
    s_setprio 2
    s_waitcnt vmcnt(8)
    s_nop 0
    ds_read_b128 v[176:179], v12 offset:0
    ds_read_b128 v[180:183], v12 offset:2048
    ds_read_b128 v[184:187], v13 offset:0
    ds_read_b128 v[188:191], v13 offset:2048
    ds_read_b128 v[128:131], v14 offset:0
    ds_read_b128 v[132:135], v15 offset:3584
    ds_read_b128 v[136:139], v16 offset:7168
    ds_read_b128 v[140:143], v17 offset:10752
    ds_read_b128 v[144:147], v16 offset:0
    ds_read_b128 v[148:151], v17 offset:3584
    ds_read_b128 v[152:155], v14 offset:7168
    ds_read_b128 v[156:159], v15 offset:10752
    s_waitcnt lgkmcnt(4)
    s_add_u32 m0, s41, 0
    s_add_u32 s42, s76, 384
    buffer_load_dwordx4 v31, s[48:51], s42 offen lds
    buffer_load_dwordx4 v11, s[48:51], s42 offen offset:1024 lds
    s_add_u32 m0, s41, 2048
    s_nop 0
    buffer_load_dwordx4 v31, s[64:67], s42 offen lds
    buffer_load_dwordx4 v11, s[64:67], s42 offen offset:1024 lds
    s_waitcnt vmcnt(8)
    v_mfma_f32_16x16x32_bf16 v[64:67], v[128:131], v[176:179], 0
    ds_read_b128 v[192:195], v12 offset:4096
    v_mfma_f32_16x16x32_bf16 v[80:83], v[128:131], v[180:183], 0
    ds_read_b128 v[196:199], v12 offset:6144
    v_mfma_f32_16x16x32_bf16 v[68:71], v[132:135], v[176:179], 0
    ds_read_b128 v[200:203], v13 offset:4096
    v_mfma_f32_16x16x32_bf16 v[84:87], v[132:135], v[180:183], 0
    ds_read_b128 v[204:207], v13 offset:6144
    v_mfma_f32_16x16x32_bf16 v[72:75], v[136:139], v[176:179], 0
    ds_read_b128 v[160:163], v14 offset:128
    v_mfma_f32_16x16x32_bf16 v[88:91], v[136:139], v[180:183], 0
    ds_read_b128 v[164:167], v15 offset:3712
    v_mfma_f32_16x16x32_bf16 v[76:79], v[140:143], v[176:179], 0
    ds_read_b128 v[168:171], v16 offset:7296
    v_mfma_f32_16x16x32_bf16 v[92:95], v[140:143], v[180:183], 0
    ds_read_b128 v[172:175], v17 offset:10880
    s_waitcnt lgkmcnt(8)
    s_waitcnt lgkmcnt(4)
    v_mfma_f32_16x16x32_bf16 v[64:67], v[144:147], v[184:187], v[64:67]
    ds_read_b128 v[128:131], v16 offset:128
    v_mfma_f32_16x16x32_bf16 v[80:83], v[144:147], v[188:191], v[80:83]
    ds_read_b128 v[132:135], v17 offset:3712
    v_mfma_f32_16x16x32_bf16 v[68:71], v[148:151], v[184:187], v[68:71]
    ds_read_b128 v[136:139], v14 offset:7296
    v_mfma_f32_16x16x32_bf16 v[84:87], v[148:151], v[188:191], v[84:87]
    ds_read_b128 v[140:143], v15 offset:10880
    v_mfma_f32_16x16x32_bf16 v[72:75], v[152:155], v[184:187], v[72:75]
    s_add_u32 m0, s41, 4096
    s_add_u32 s42, s76, 512
    v_mfma_f32_16x16x32_bf16 v[88:91], v[152:155], v[188:191], v[88:91]
    buffer_load_dwordx4 v31, s[48:51], s42 offen lds
    v_mfma_f32_16x16x32_bf16 v[76:79], v[156:159], v[184:187], v[76:79]
    buffer_load_dwordx4 v11, s[48:51], s42 offen offset:1024 lds
    v_mfma_f32_16x16x32_bf16 v[92:95], v[156:159], v[188:191], v[92:95]
    s_add_u32 m0, s41, 6144
    s_nop 0
    buffer_load_dwordx4 v31, s[64:67], s42 offen lds
    buffer_load_dwordx4 v11, s[64:67], s42 offen offset:1024 lds
    s_waitcnt lgkmcnt(4)
    s_waitcnt vmcnt(8)
    s_nop 0
    v_mfma_f32_16x16x32_bf16 v[64:67], v[160:163], v[192:195], v[64:67]
    ds_read_b128 v[176:179], v12 offset:8192
    v_mfma_f32_16x16x32_bf16 v[80:83], v[160:163], v[196:199], v[80:83]
    ds_read_b128 v[180:183], v12 offset:10240
    v_mfma_f32_16x16x32_bf16 v[68:71], v[164:167], v[192:195], v[68:71]
    ds_read_b128 v[184:187], v13 offset:8192
    v_mfma_f32_16x16x32_bf16 v[84:87], v[164:167], v[196:199], v[84:87]
    ds_read_b128 v[188:191], v13 offset:10240
    v_mfma_f32_16x16x32_bf16 v[72:75], v[168:171], v[192:195], v[72:75]
    ds_read_b128 v[144:147], v14 offset:256
    v_mfma_f32_16x16x32_bf16 v[88:91], v[168:171], v[196:199], v[88:91]
    ds_read_b128 v[148:151], v15 offset:3840
    v_mfma_f32_16x16x32_bf16 v[76:79], v[172:175], v[192:195], v[76:79]
    ds_read_b128 v[152:155], v16 offset:7424
    v_mfma_f32_16x16x32_bf16 v[92:95], v[172:175], v[196:199], v[92:95]
    ds_read_b128 v[156:159], v17 offset:11008
    s_waitcnt lgkmcnt(8)
    s_waitcnt lgkmcnt(4)
    v_mfma_f32_16x16x32_bf16 v[64:67], v[128:131], v[200:203], v[64:67]
    ds_read_b128 v[160:163], v16 offset:256
    v_mfma_f32_16x16x32_bf16 v[80:83], v[128:131], v[204:207], v[80:83]
    ds_read_b128 v[164:167], v17 offset:3840
    v_mfma_f32_16x16x32_bf16 v[68:71], v[132:135], v[200:203], v[68:71]
    ds_read_b128 v[168:171], v14 offset:7424
    v_mfma_f32_16x16x32_bf16 v[84:87], v[132:135], v[204:207], v[84:87]
    ds_read_b128 v[172:175], v15 offset:11008
    v_mfma_f32_16x16x32_bf16 v[72:75], v[136:139], v[200:203], v[72:75]
    s_add_u32 m0, s41, 8192
    s_add_u32 s42, s76, 640
    v_mfma_f32_16x16x32_bf16 v[88:91], v[136:139], v[204:207], v[88:91]
    buffer_load_dwordx4 v31, s[48:51], s42 offen lds
    v_mfma_f32_16x16x32_bf16 v[76:79], v[140:143], v[200:203], v[76:79]
    buffer_load_dwordx4 v11, s[48:51], s42 offen offset:1024 lds
    v_mfma_f32_16x16x32_bf16 v[92:95], v[140:143], v[204:207], v[92:95]
    s_add_u32 m0, s41, 10240
    s_nop 0
    buffer_load_dwordx4 v31, s[64:67], s42 offen lds
    buffer_load_dwordx4 v11, s[64:67], s42 offen offset:1024 lds
    s_waitcnt lgkmcnt(4)
    s_waitcnt vmcnt(8)
    s_nop 0
    v_mfma_f32_16x16x32_bf16 v[64:67], v[144:147], v[176:179], v[64:67]
    ds_read_b128 v[192:195], v12 offset:0
    v_mfma_f32_16x16x32_bf16 v[80:83], v[144:147], v[180:183], v[80:83]
    ds_read_b128 v[196:199], v12 offset:2048
    v_mfma_f32_16x16x32_bf16 v[68:71], v[148:151], v[176:179], v[68:71]
    ds_read_b128 v[200:203], v13 offset:0
    v_mfma_f32_16x16x32_bf16 v[84:87], v[148:151], v[180:183], v[84:87]
    ds_read_b128 v[204:207], v13 offset:2048
    v_mfma_f32_16x16x32_bf16 v[72:75], v[152:155], v[176:179], v[72:75]
    ds_read_b128 v[128:131], v14 offset:384
    v_mfma_f32_16x16x32_bf16 v[88:91], v[152:155], v[180:183], v[88:91]
    ds_read_b128 v[132:135], v15 offset:3968
    v_mfma_f32_16x16x32_bf16 v[76:79], v[156:159], v[176:179], v[76:79]
    ds_read_b128 v[136:139], v16 offset:7552
    v_mfma_f32_16x16x32_bf16 v[92:95], v[156:159], v[180:183], v[92:95]
    ds_read_b128 v[140:143], v17 offset:11136
    s_waitcnt lgkmcnt(8)
    s_waitcnt lgkmcnt(4)
    v_mfma_f32_16x16x32_bf16 v[64:67], v[160:163], v[184:187], v[64:67]
    ds_read_b128 v[144:147], v16 offset:384
    v_mfma_f32_16x16x32_bf16 v[80:83], v[160:163], v[188:191], v[80:83]
    ds_read_b128 v[148:151], v17 offset:3968
    v_mfma_f32_16x16x32_bf16 v[68:71], v[164:167], v[184:187], v[68:71]
    ds_read_b128 v[152:155], v14 offset:7552
    v_mfma_f32_16x16x32_bf16 v[84:87], v[164:167], v[188:191], v[84:87]
    ds_read_b128 v[156:159], v15 offset:11136
    v_mfma_f32_16x16x32_bf16 v[72:75], v[168:171], v[184:187], v[72:75]
    s_add_u32 m0, s41, 0
    s_nop 0
    s_add_u32 s42, s76, 768
    v_mfma_f32_16x16x32_bf16 v[88:91], v[168:171], v[188:191], v[88:91]
    buffer_load_dwordx4 v31, s[48:51], s42 offen lds
    v_mfma_f32_16x16x32_bf16 v[76:79], v[172:175], v[184:187], v[76:79]
    buffer_load_dwordx4 v11, s[48:51], s42 offen offset:1024 lds
    v_mfma_f32_16x16x32_bf16 v[92:95], v[172:175], v[188:191], v[92:95]
    s_add_u32 m0, s41, 2048
    s_nop 0
    s_nop 0
    buffer_load_dwordx4 v31, s[64:67], s42 offen lds
    buffer_load_dwordx4 v11, s[64:67], s42 offen offset:1024 lds
    v_mov_b32 v2, 158228
    v_mov_b32 v3, 1
    s_mov_b64 exec, 1
    ds_add_u32 v2, v3
    s_mov_b64 exec, -1
    s_waitcnt lgkmcnt(5)
    s_waitcnt vmcnt(8)
    s_nop 0
    v_mfma_f32_16x16x32_bf16 v[64:67], v[128:131], v[192:195], v[64:67]
    ds_read_b128 v[176:179], v12 offset:4096
    v_mfma_f32_16x16x32_bf16 v[80:83], v[128:131], v[196:199], v[80:83]
    ds_read_b128 v[180:183], v12 offset:6144
    v_mfma_f32_16x16x32_bf16 v[68:71], v[132:135], v[192:195], v[68:71]
    ds_read_b128 v[184:187], v13 offset:4096
    v_mfma_f32_16x16x32_bf16 v[84:87], v[132:135], v[196:199], v[84:87]
    ds_read_b128 v[188:191], v13 offset:6144
    v_mfma_f32_16x16x32_bf16 v[72:75], v[136:139], v[192:195], v[72:75]
    ds_read_b128 v[160:163], v14 offset:512
    v_mfma_f32_16x16x32_bf16 v[88:91], v[136:139], v[196:199], v[88:91]
    ds_read_b128 v[164:167], v15 offset:4096
    v_mfma_f32_16x16x32_bf16 v[76:79], v[140:143], v[192:195], v[76:79]
    ds_read_b128 v[168:171], v16 offset:7680
    v_mfma_f32_16x16x32_bf16 v[92:95], v[140:143], v[196:199], v[92:95]
    ds_read_b128 v[172:175], v17 offset:11264
    s_waitcnt lgkmcnt(9)
    s_waitcnt lgkmcnt(4)
    v_mfma_f32_16x16x32_bf16 v[64:67], v[144:147], v[200:203], v[64:67]
    ds_read_b128 v[128:131], v16 offset:512
    v_mfma_f32_16x16x32_bf16 v[80:83], v[144:147], v[204:207], v[80:83]
    ds_read_b128 v[132:135], v17 offset:4096
    v_mfma_f32_16x16x32_bf16 v[68:71], v[148:151], v[200:203], v[68:71]
    ds_read_b128 v[136:139], v14 offset:7680
    v_mfma_f32_16x16x32_bf16 v[84:87], v[148:151], v[204:207], v[84:87]
    ds_read_b128 v[140:143], v15 offset:11264
    v_mfma_f32_16x16x32_bf16 v[72:75], v[152:155], v[200:203], v[72:75]
    v_mfma_f32_16x16x32_bf16 v[88:91], v[152:155], v[204:207], v[88:91]
    v_mfma_f32_16x16x32_bf16 v[76:79], v[156:159], v[200:203], v[76:79]
    v_mfma_f32_16x16x32_bf16 v[92:95], v[156:159], v[204:207], v[92:95]
    s_waitcnt lgkmcnt(4)
    s_waitcnt vmcnt(4)
    v_mfma_f32_16x16x32_bf16 v[64:67], v[160:163], v[176:179], v[64:67]
    ds_read_b128 v[192:195], v12 offset:8192
    v_mfma_f32_16x16x32_bf16 v[80:83], v[160:163], v[180:183], v[80:83]
    ds_read_b128 v[196:199], v12 offset:10240
    v_mfma_f32_16x16x32_bf16 v[68:71], v[164:167], v[176:179], v[68:71]
    ds_read_b128 v[200:203], v13 offset:8192
    v_mfma_f32_16x16x32_bf16 v[84:87], v[164:167], v[180:183], v[84:87]
    ds_read_b128 v[204:207], v13 offset:10240
    v_mfma_f32_16x16x32_bf16 v[72:75], v[168:171], v[176:179], v[72:75]
    ds_read_b128 v[144:147], v14 offset:640
    v_mfma_f32_16x16x32_bf16 v[88:91], v[168:171], v[180:183], v[88:91]
    ds_read_b128 v[148:151], v15 offset:4224
    v_mfma_f32_16x16x32_bf16 v[76:79], v[172:175], v[176:179], v[76:79]
    ds_read_b128 v[152:155], v16 offset:7808
    v_mfma_f32_16x16x32_bf16 v[92:95], v[172:175], v[180:183], v[92:95]
    ds_read_b128 v[156:159], v17 offset:11392
    s_waitcnt lgkmcnt(8)
    s_waitcnt lgkmcnt(4)
    v_mfma_f32_16x16x32_bf16 v[64:67], v[128:131], v[184:187], v[64:67]
    ds_read_b128 v[160:163], v16 offset:640
    v_mfma_f32_16x16x32_bf16 v[80:83], v[128:131], v[188:191], v[80:83]
    ds_read_b128 v[164:167], v17 offset:4224
    v_mfma_f32_16x16x32_bf16 v[68:71], v[132:135], v[184:187], v[68:71]
    ds_read_b128 v[168:171], v14 offset:7808
    v_mfma_f32_16x16x32_bf16 v[84:87], v[132:135], v[188:191], v[84:87]
    ds_read_b128 v[172:175], v15 offset:11392
    v_mfma_f32_16x16x32_bf16 v[72:75], v[136:139], v[184:187], v[72:75]
    v_mfma_f32_16x16x32_bf16 v[88:91], v[136:139], v[188:191], v[88:91]
    v_mfma_f32_16x16x32_bf16 v[76:79], v[140:143], v[184:187], v[76:79]
    v_mfma_f32_16x16x32_bf16 v[92:95], v[140:143], v[188:191], v[92:95]
    s_waitcnt lgkmcnt(4)
    s_waitcnt vmcnt(0)
    v_mfma_f32_16x16x32_bf16 v[64:67], v[144:147], v[192:195], v[64:67]
    ds_read_b128 v[176:179], v12 offset:0
    v_mfma_f32_16x16x32_bf16 v[80:83], v[144:147], v[196:199], v[80:83]
    ds_read_b128 v[180:183], v12 offset:2048
    v_mfma_f32_16x16x32_bf16 v[68:71], v[148:151], v[192:195], v[68:71]
    ds_read_b128 v[184:187], v13 offset:0
    v_mfma_f32_16x16x32_bf16 v[84:87], v[148:151], v[196:199], v[84:87]
    ds_read_b128 v[188:191], v13 offset:2048
    v_mfma_f32_16x16x32_bf16 v[72:75], v[152:155], v[192:195], v[72:75]
    ds_read_b128 v[128:131], v14 offset:768
    v_mfma_f32_16x16x32_bf16 v[88:91], v[152:155], v[196:199], v[88:91]
    ds_read_b128 v[132:135], v15 offset:4352
    v_mfma_f32_16x16x32_bf16 v[76:79], v[156:159], v[192:195], v[76:79]
    ds_read_b128 v[136:139], v16 offset:7936
    v_mfma_f32_16x16x32_bf16 v[92:95], v[156:159], v[196:199], v[92:95]
    ds_read_b128 v[140:143], v17 offset:11520
    s_waitcnt lgkmcnt(8)
    s_waitcnt lgkmcnt(4)
    v_mfma_f32_16x16x32_bf16 v[64:67], v[160:163], v[200:203], v[64:67]
    ds_read_b128 v[144:147], v16 offset:768
    v_mfma_f32_16x16x32_bf16 v[80:83], v[160:163], v[204:207], v[80:83]
    ds_read_b128 v[148:151], v17 offset:4352
    v_mfma_f32_16x16x32_bf16 v[68:71], v[164:167], v[200:203], v[68:71]
    ds_read_b128 v[152:155], v14 offset:7936
    v_mfma_f32_16x16x32_bf16 v[84:87], v[164:167], v[204:207], v[84:87]
    ds_read_b128 v[156:159], v15 offset:11520
    v_mfma_f32_16x16x32_bf16 v[72:75], v[168:171], v[200:203], v[72:75]
    v_mfma_f32_16x16x32_bf16 v[88:91], v[168:171], v[204:207], v[88:91]
    v_mfma_f32_16x16x32_bf16 v[76:79], v[172:175], v[200:203], v[76:79]
    v_mfma_f32_16x16x32_bf16 v[92:95], v[172:175], v[204:207], v[92:95]
    s_waitcnt lgkmcnt(4)
    s_nop 0
    v_mfma_f32_16x16x32_bf16 v[64:67], v[128:131], v[176:179], v[64:67]
    v_mfma_f32_16x16x32_bf16 v[80:83], v[128:131], v[180:183], v[80:83]
    v_mfma_f32_16x16x32_bf16 v[68:71], v[132:135], v[176:179], v[68:71]
    v_mfma_f32_16x16x32_bf16 v[84:87], v[132:135], v[180:183], v[84:87]
    v_mfma_f32_16x16x32_bf16 v[72:75], v[136:139], v[176:179], v[72:75]
    v_mfma_f32_16x16x32_bf16 v[88:91], v[136:139], v[180:183], v[88:91]
    v_mfma_f32_16x16x32_bf16 v[76:79], v[140:143], v[176:179], v[76:79]
    v_mfma_f32_16x16x32_bf16 v[92:95], v[140:143], v[180:183], v[92:95]
    s_waitcnt lgkmcnt(0)
    s_nop 0
    v_mfma_f32_16x16x32_bf16 v[64:67], v[144:147], v[184:187], v[64:67]
    v_mfma_f32_16x16x32_bf16 v[80:83], v[144:147], v[188:191], v[80:83]
    v_mfma_f32_16x16x32_bf16 v[68:71], v[148:151], v[184:187], v[68:71]
    v_mfma_f32_16x16x32_bf16 v[84:87], v[148:151], v[188:191], v[84:87]
    v_mfma_f32_16x16x32_bf16 v[72:75], v[152:155], v[184:187], v[72:75]
    v_mfma_f32_16x16x32_bf16 v[88:91], v[152:155], v[188:191], v[88:91]
    v_mfma_f32_16x16x32_bf16 v[76:79], v[156:159], v[184:187], v[76:79]
    v_mfma_f32_16x16x32_bf16 v[92:95], v[156:159], v[188:191], v[92:95]
    s_setprio 0
    s_waitcnt lgkmcnt(0)
    v_mov_b32 v2, 158208
    v_mov_b32 v3, 1
    s_mov_b64 exec, 1
    ds_add_u32 v2, v3
    s_mov_b64 exec, -1
    s_cmp_eq_u32 s40, 4
    s_cbranch_scc0 K1_RDY2
K1_RDY1:
    s_waitcnt vmcnt(0)
    s_mov_b64 exec, 0x7f
    v_cmp_ne_u32 vcc, 1, v251
    s_mov_b64 exec, -1
    s_cbranch_vccnz K1_RDYS
    v_mov_b32 v2, 158212
    v_mov_b32 v3, 1
    s_mov_b64 exec, 1
    ds_add_u32 v2, v3
    s_mov_b64 exec, -1
K1_RDY2:
    v_lshrrev_b32 v7, 4, v1
    v_lshlrev_b32 v4, 6, v7
    v_add_u32 v4, 155648, v4
    ds_read_b128 v[32:35], v4 offset:0
    ds_read_b128 v[36:39], v4 offset:16
    ds_read_b128 v[40:43], v4 offset:32
    ds_read_b128 v[44:47], v4 offset:48
    s_waitcnt lgkmcnt(0)
    v_mul_f32 v8, v32, v64
    v_mul_f32 v9, v32, v80
    v_mul_f32 v64, v116, v8
    v_mul_f32_e64 v80, v116, v9
    v_fma_f32 v64, -v117, v9, v64
    v_fmac_f32 v80, v117, v8
    v_mov_b32 v2, v64
    v_mov_b32 v3, v80
    v_mul_f32 v8, v33, v65
    v_mul_f32 v9, v33, v81
    v_mul_f32 v65, v116, v8
    v_mul_f32_e64 v81, v116, v9
    v_fma_f32 v65, -v117, v9, v65
    v_fmac_f32_e64 v81, v117, v8
    v_fma_f32 v4, v104, v2, v65
    v_fma_f32 v5, v104, v3, v81
    v_fma_f32 v4, -v105, v3, v4
    v_fmac_f32 v5, v105, v2
    v_mul_f32 v8, v34, v66
    v_mul_f32 v9, v34, v82
    v_mul_f32 v66, v116, v8
    v_mul_f32_e64 v82, v116, v9
    v_fma_f32 v66, -v117, v9, v66
    v_fmac_f32_e64 v82, v117, v8
    v_fma_f32 v2, v104, v4, v66
    v_fma_f32 v3, v104, v5, v82
    v_fma_f32 v2, -v105, v5, v2
    v_fmac_f32 v3, v105, v4
    v_mul_f32 v8, v35, v67
    v_mul_f32 v9, v35, v83
    v_mul_f32 v67, v116, v8
    v_mul_f32_e64 v83, v116, v9
    v_fma_f32 v67, -v117, v9, v67
    v_fmac_f32_e64 v83, v117, v8
    v_fma_f32 v4, v104, v2, v67
    v_fma_f32 v5, v104, v3, v83
    v_fma_f32 v4, -v105, v3, v4
    v_fmac_f32 v5, v105, v2
    v_mul_f32 v8, v36, v68
    v_mul_f32 v9, v36, v84
    v_mul_f32 v68, v116, v8
    v_mul_f32_e64 v84, v116, v9
    v_fma_f32 v68, -v117, v9, v68
    v_fmac_f32_e64 v84, v117, v8
    v_fma_f32 v2, v104, v4, v68
    v_fma_f32 v3, v104, v5, v84
    v_fma_f32 v2, -v105, v5, v2
    v_fmac_f32 v3, v105, v4
    v_mul_f32 v8, v37, v69
    v_mul_f32 v9, v37, v85
    v_mul_f32 v69, v116, v8
    v_mul_f32_e64 v85, v116, v9
    v_fma_f32 v69, -v117, v9, v69
    v_fmac_f32_e64 v85, v117, v8
    v_fma_f32 v4, v104, v2, v69
    v_fma_f32 v5, v104, v3, v85
    v_fma_f32 v4, -v105, v3, v4
    v_fmac_f32 v5, v105, v2
    v_mul_f32 v8, v38, v70
    v_mul_f32 v9, v38, v86
    v_mul_f32 v70, v116, v8
    v_mul_f32_e64 v86, v116, v9
    v_fma_f32 v70, -v117, v9, v70
    v_fmac_f32_e64 v86, v117, v8
    v_fma_f32 v2, v104, v4, v70
    v_fma_f32 v3, v104, v5, v86
    v_fma_f32 v2, -v105, v5, v2
    v_fmac_f32 v3, v105, v4
    v_mul_f32 v8, v39, v71
    v_mul_f32 v9, v39, v87
    v_mul_f32 v71, v116, v8
    v_mul_f32_e64 v87, v116, v9
    v_fma_f32 v71, -v117, v9, v71
    v_fmac_f32_e64 v87, v117, v8
    v_fma_f32 v4, v104, v2, v71
    v_fma_f32 v5, v104, v3, v87
    v_fma_f32 v4, -v105, v3, v4
    v_fmac_f32 v5, v105, v2
    v_mul_f32 v8, v40, v72
    v_mul_f32 v9, v40, v88
    v_mul_f32 v72, v116, v8
    v_mul_f32_e64 v88, v116, v9
    v_fma_f32 v72, -v117, v9, v72
    v_fmac_f32_e64 v88, v117, v8
    v_fma_f32 v2, v104, v4, v72
    v_fma_f32 v3, v104, v5, v88
    v_fma_f32 v2, -v105, v5, v2
    v_fmac_f32 v3, v105, v4
    v_mul_f32 v8, v41, v73
    v_mul_f32 v9, v41, v89
    v_mul_f32 v73, v116, v8
    v_mul_f32_e64 v89, v116, v9
    v_fma_f32 v73, -v117, v9, v73
    v_fmac_f32_e64 v89, v117, v8
    v_fma_f32 v4, v104, v2, v73
    v_fma_f32 v5, v104, v3, v89
    v_fma_f32 v4, -v105, v3, v4
    v_fmac_f32 v5, v105, v2
    v_mul_f32 v8, v42, v74
    v_mul_f32 v9, v42, v90
    v_mul_f32 v74, v116, v8
    v_mul_f32_e64 v90, v116, v9
    v_fma_f32 v74, -v117, v9, v74
    v_fmac_f32_e64 v90, v117, v8
    v_fma_f32 v2, v104, v4, v74
    v_fma_f32 v3, v104, v5, v90
    v_fma_f32 v2, -v105, v5, v2
    v_fmac_f32 v3, v105, v4
    v_mul_f32 v8, v43, v75
    v_mul_f32 v9, v43, v91
    v_mul_f32 v75, v116, v8
    v_mul_f32_e64 v91, v116, v9
    v_fma_f32 v75, -v117, v9, v75
    v_fmac_f32_e64 v91, v117, v8
    v_fma_f32 v4, v104, v2, v75
    v_fma_f32 v5, v104, v3, v91
    v_fma_f32 v4, -v105, v3, v4
    v_fmac_f32 v5, v105, v2
    v_mul_f32 v8, v44, v76
    v_mul_f32 v9, v44, v92
    v_mul_f32 v76, v116, v8
    v_mul_f32_e64 v92, v116, v9
    v_fma_f32 v76, -v117, v9, v76
    v_fmac_f32_e64 v92, v117, v8
    v_fma_f32 v2, v104, v4, v76
    v_fma_f32 v3, v104, v5, v92
    v_fma_f32 v2, -v105, v5, v2
    v_fmac_f32 v3, v105, v4
    v_mul_f32 v8, v45, v77
    v_mul_f32 v9, v45, v93
    v_mul_f32 v77, v116, v8
    v_mul_f32_e64 v93, v116, v9
    v_fma_f32 v77, -v117, v9, v77
    v_fmac_f32_e64 v93, v117, v8
    v_fma_f32 v4, v104, v2, v77
    v_fma_f32 v5, v104, v3, v93
    v_fma_f32 v4, -v105, v3, v4
    v_fmac_f32 v5, v105, v2
    v_mul_f32 v8, v46, v78
    v_mul_f32 v9, v46, v94
    v_mul_f32 v78, v116, v8
    v_mul_f32_e64 v94, v116, v9
    v_fma_f32 v78, -v117, v9, v78
    v_fmac_f32_e64 v94, v117, v8
    v_fma_f32 v2, v104, v4, v78
    v_fma_f32 v3, v104, v5, v94
    v_fma_f32 v2, -v105, v5, v2
    v_fmac_f32 v3, v105, v4
    v_mul_f32 v8, v47, v79
    v_mul_f32 v9, v47, v95
    v_mul_f32 v79, v116, v8
    v_mul_f32_e64 v95, v116, v9
    v_fma_f32 v79, -v117, v9, v79
    v_fmac_f32_e64 v95, v117, v8
    v_fma_f32 v4, v104, v2, v79
    v_fma_f32 v5, v104, v3, v95
    v_fma_f32 v4, -v105, v3, v4
    v_fmac_f32_e64 v5, v105, v2
    ds_write_b64 v245, v[4:5]
    s_waitcnt lgkmcnt(0)
    ds_read_b128 v[32:35], v244
    ds_read_b128 v[36:39], v244 offset:16
    s_waitcnt lgkmcnt(0)
    v_fma_f32 v40, v106, v32, v34
    v_fma_f32 v41, v106, v33, v35
    v_fma_f32 v40, -v107, v33, v40
    v_fmac_f32_e64 v41, v107, v32
    v_fma_f32 v42, v106, v40, v36
    v_fma_f32 v43, v106, v41, v37
    v_fma_f32 v42, -v107, v41, v42
    v_fmac_f32_e64 v43, v107, v40
    v_fma_f32 v44, v106, v42, v38
    v_fma_f32 v45, v106, v43, v39
    v_fma_f32 v44, -v107, v43, v44
    v_fmac_f32 v45, v107, v42
    v_mov_b32 v46, 1
    v_mov_b32 v47, 0
    s_waitcnt lgkmcnt(0)
    v_mov_b32 v2, 158212
K1_SPIN6:
    ds_read_b32 v3, v2
    s_waitcnt lgkmcnt(0)
    v_readfirstlane_b32 s42, v3
    s_nop 2
    s_cmp_ge_u32 s42, 1
    s_cbranch_scc0 K1_SPIN6_S
    s_nop 0
    s_mov_b32 s42, 262144
    s_mov_b64 exec, 0xffff
    buffer_store_dwordx4 v[44:47], v250, s[68:71], s42 offen sc1
    s_mov_b64 exec, -1
    v_mov_b32 v122, 0
    v_mov_b32 v123, 0
    v_cmp_eq_u32 vcc, 1, v7
    s_nop 1
    v_cndmask_b32 v122, v122, v32, vcc
    v_cndmask_b32 v123, v123, v33, vcc
    v_cmp_eq_u32 vcc, 2, v7
    s_nop 1
    v_cndmask_b32 v122, v122, v40, vcc
    v_cndmask_b32 v123, v123, v41, vcc
    v_cmp_eq_u32 vcc, 3, v7
    s_nop 1
    v_cndmask_b32 v122, v122, v42, vcc
    v_cndmask_b32 v123, v123, v43, vcc
    s_setprio 0
    v_mov_b32 v2, 158216
K1_SPIN7:
    ds_read_b32 v3, v2
    s_waitcnt lgkmcnt(0)
    v_readfirstlane_b32 s42, v3
    s_nop 2
    s_cmp_ge_u32 s42, 4
    s_cbranch_scc0 K1_SPIN7_S
    s_cmp_eq_u32 s40, 7
    s_cbranch_scc1 K1_W7T
    v_mov_b32 v2, 158208
K1_SPIN8:
    ds_read_b32 v3, v2
    s_waitcnt lgkmcnt(0)
    v_readfirstlane_b32 s42, v3
    s_nop 2
    s_cmp_ge_u32 s42, 4
    s_cbranch_scc0 K1_SPIN8_S
    s_add_u32 m0, s78, 8192
    s_add_u32 s42, s80, 0
    s_nop 0
    buffer_load_dwordx4 v29, s[52:55], s42 offen lds
    buffer_load_dwordx4 v30, s[52:55], s42 offen offset:1024 lds
    s_add_u32 m0, s78, 10240
    s_add_u32 s42, s80, 14336
    buffer_load_dwordx4 v29, s[52:55], s42 offen lds
    buffer_load_dwordx4 v30, s[52:55], s42 offen offset:1024 lds
    s_add_u32 m0, s78, 0
    s_nop 0
    s_add_u32 s42, s80, 28672
    buffer_load_dwordx4 v29, s[52:55], s42 offen lds
    buffer_load_dwordx4 v30, s[52:55], s42 offen offset:1024 lds
    s_add_u32 m0, s78, 2048
    s_add_u32 s42, s80, 43008
    buffer_load_dwordx4 v29, s[52:55], s42 offen lds
    buffer_load_dwordx4 v30, s[52:55], s42 offen offset:1024 lds
    s_add_u32 m0, s78, 4096
    s_add_u32 s42, s80, 57344
    buffer_load_dwordx4 v29, s[52:55], s42 offen lds
    buffer_load_dwordx4 v30, s[52:55], s42 offen offset:1024 lds
    s_add_u32 m0, s78, 6144
    s_add_u32 s42, s80, 71680
    buffer_load_dwordx4 v29, s[52:55], s42 offen lds
    buffer_load_dwordx4 v30, s[52:55], s42 offen offset:1024 lds
    s_branch K1_NOPRE
K1_W7T:
    s_mov_b32 s42, 0
    v_add_u32 v2, s42, v1
    v_mul_u32_u24 v2, 16, v2
    v_add_u32 v2, s92, v2
    v_lshlrev_b32 v2, 7, v2
    v_mov_b32 v3, 2146435072
    v_cmp_gt_u32 vcc, 28, v1
    s_nop 1
    v_cndmask_b32 v2, v3, v2, vcc
    s_mul_i32 s42, s38, 229376
    buffer_load_dword v252, v2, s[52:55], s42 offen
    s_mov_b32 s42, 28
    v_add_u32 v2, s42, v1
    v_mul_u32_u24 v2, 16, v2
    v_add_u32 v2, s92, v2
    v_lshlrev_b32 v2, 7, v2
    v_mov_b32 v3, 2146435072
    v_cmp_gt_u32 vcc, 28, v1
    s_nop 1
    v_cndmask_b32 v2, v3, v2, vcc
    s_mul_i32 s42, s38, 229376
    buffer_load_dword v252, v2, s[52:55], s42 offen
    s_mov_b32 s42, 56
    v_add_u32 v2, s42, v1
    v_mul_u32_u24 v2, 16, v2
    v_add_u32 v2, s92, v2
    v_lshlrev_b32 v2, 7, v2
    v_mov_b32 v3, 2146435072
    v_cmp_gt_u32 vcc, 28, v1
    s_nop 1
    v_cndmask_b32 v2, v3, v2, vcc
    s_nop 0
    s_mul_i32 s42, s38, 229376
    buffer_load_dword v252, v2, s[52:55], s42 offen
    s_mov_b32 s42, 84
    v_add_u32 v2, s42, v1
    v_mul_u32_u24 v2, 16, v2
    v_add_u32 v2, s92, v2
    v_lshlrev_b32 v2, 7, v2
    v_mov_b32 v3, 2146435072
    v_cmp_gt_u32 vcc, 28, v1
    s_nop 1
    v_cndmask_b32 v2, v3, v2, vcc
    s_mul_i32 s42, s38, 229376
    buffer_load_dword v252, v2, s[52:55], s42 offen
    v_mov_b32 v2, v1
    v_mul_u32_u24 v2, 16, v2
    v_add_u32 v2, s92, v2
    v_mul_u32_u24 v2, 896, v2
    v_mov_b32 v3, 2146435072
    v_cmp_gt_u32 vcc, 28, v1
    s_nop 1
    v_cndmask_b32 v2, v3, v2, vcc
    s_lshl_b32 s42, s38, 7
    buffer_load_dword v253, v2, s[56:59], s42 offen
    buffer_load_dword v254, v2, s[60:63], s42 offen
K1_NOPRE:
    s_setprio 2
K1_POLLA:
    buffer_load_dwordx4 v[44:47], v250, s[68:71], 0 offen sc1
    s_waitcnt vmcnt(0)
K1_POLLWA:
    v_cmp_ne_u32 vcc, 1, v46
    s_cbranch_vccz K1_POLLEDA
    s_sleep 4
    s_branch K1_POLLA
K1_POLLEDA:
    v_fma_f32 v4, v108, v44, v122
    v_fma_f32 v5, v108, v45, v123
    v_fma_f32 v4, -v109, v45, v4
    v_fmac_f32_e64 v5, v109, v44
    v_fma_f32 v2, v104, v4, v64
    v_fma_f32 v3, v104, v5, v80
    v_fma_f32 v2, -v105, v5, v2
    v_fmac_f32_e64 v3, v105, v4
    v_fma_f32 v4, v104, v2, v65
    v_fma_f32 v5, v104, v3, v81
    v_fma_f32 v4, -v105, v3, v4
    v_fmac_f32_e64 v5, v105, v2
    v_cvt_pk_bf16_f32 v32, v2, v4
    v_cvt_pk_bf16_f32 v40, -v3, -v5
    v_fma_f32 v2, v104, v4, v66
    v_fma_f32 v3, v104, v5, v82
    v_fma_f32 v2, -v105, v5, v2
    v_fmac_f32_e64 v3, v105, v4
    v_fma_f32 v4, v104, v2, v67
    v_fma_f32 v5, v104, v3, v83
    v_fma_f32 v4, -v105, v3, v4
    v_fmac_f32_e64 v5, v105, v2
    v_cvt_pk_bf16_f32 v33, v2, v4
    v_cvt_pk_bf16_f32 v41, -v3, -v5
    v_fma_f32 v2, v104, v4, v68
    v_fma_f32 v3, v104, v5, v84
    v_fma_f32 v2, -v105, v5, v2
    v_fmac_f32_e64 v3, v105, v4
    v_fma_f32 v4, v104, v2, v69
    v_fma_f32 v5, v104, v3, v85
    v_fma_f32 v4, -v105, v3, v4
    v_fmac_f32_e64 v5, v105, v2
    v_cvt_pk_bf16_f32 v34, v2, v4
    v_cvt_pk_bf16_f32 v42, -v3, -v5
    v_fma_f32 v2, v104, v4, v70
    v_fma_f32 v3, v104, v5, v86
    v_fma_f32 v2, -v105, v5, v2
    v_fmac_f32_e64 v3, v105, v4
    v_fma_f32 v4, v104, v2, v71
    v_fma_f32 v5, v104, v3, v87
    v_fma_f32 v4, -v105, v3, v4
    v_fmac_f32_e64 v5, v105, v2
    v_cvt_pk_bf16_f32 v35, v2, v4
    v_cvt_pk_bf16_f32 v43, -v3, -v5
    v_fma_f32 v2, v104, v4, v72
    v_fma_f32 v3, v104, v5, v88
    v_fma_f32 v2, -v105, v5, v2
    v_fmac_f32_e64 v3, v105, v4
    v_fma_f32 v4, v104, v2, v73
    v_fma_f32 v5, v104, v3, v89
    v_fma_f32 v4, -v105, v3, v4
    v_fmac_f32_e64 v5, v105, v2
    v_cvt_pk_bf16_f32 v36, v2, v4
    v_cvt_pk_bf16_f32 v44, -v3, -v5
    v_fma_f32 v2, v104, v4, v74
    v_fma_f32 v3, v104, v5, v90
    v_fma_f32 v2, -v105, v5, v2
    v_fmac_f32_e64 v3, v105, v4
    v_fma_f32 v4, v104, v2, v75
    v_fma_f32 v5, v104, v3, v91
    v_fma_f32 v4, -v105, v3, v4
    v_fmac_f32_e64 v5, v105, v2
    v_cvt_pk_bf16_f32 v37, v2, v4
    v_cvt_pk_bf16_f32 v45, -v3, -v5
    v_fma_f32 v2, v104, v4, v76
    v_fma_f32 v3, v104, v5, v92
    v_fma_f32 v2, -v105, v5, v2
    v_fmac_f32_e64 v3, v105, v4
    v_fma_f32 v4, v104, v2, v77
    v_fma_f32 v5, v104, v3, v93
    v_fma_f32 v4, -v105, v3, v4
    v_fmac_f32_e64 v5, v105, v2
    v_cvt_pk_bf16_f32 v38, v2, v4
    v_cvt_pk_bf16_f32 v46, -v3, -v5
    v_fma_f32 v2, v104, v4, v78
    v_fma_f32 v3, v104, v5, v94
    v_fma_f32 v2, -v105, v5, v2
    v_fmac_f32_e64 v3, v105, v4
    v_fma_f32 v4, v104, v2, v79
    v_fma_f32 v5, v104, v3, v95
    v_fma_f32 v4, -v105, v3, v4
    v_fmac_f32_e64 v5, v105, v2
    v_cvt_pk_bf16_f32 v39, v2, v4
    v_cvt_pk_bf16_f32 v47, -v3, -v5
    ds_write_b128 v246, v[32:35] offset:8192
    ds_write_b128 v246, v[36:39] offset:8208
    ds_write_b128 v246, v[40:43] offset:10240
    ds_write_b128 v246, v[44:47] offset:10256
    s_waitcnt lgkmcnt(0)
    v_mov_b32 v2, 158224
    v_mov_b32 v3, 1
    s_mov_b64 exec, 1
    ds_add_u32 v2, v3
    s_mov_b64 exec, -1
    s_setprio 0
    s_cmp_eq_u32 s40, 7
    s_cbranch_scc0 K1_G3
    v_and_b32 v3, 31, v1
    v_lshrrev_b32 v4, 5, v1
    s_lshr_b32 s42, s40, 2
    s_lshl_b32 s42, s42, 5
    s_and_b32 s43, s40, 1
    s_lshl_b32 s43, s43, 4
    s_add_u32 s42, s42, s43
    v_lshl_add_u32 v6, v4, 2, s42
    s_bfe_u32 s42, s40, 0x10001
    s_lshl_b32 s42, s42, 5
    s_lshl_b32 s43, s38, 6
    s_add_u32 s42, s42, s43
    v_add_u32 v5, s42, v3
    s_lshl_b32 s42, s39, 6
    v_add_u32 v7, s42, v6
    v_mul_u32_u24 v8, 896, v7
    v_lshl_add_u32 v8, v5, 1, v8
    v_add_u32 v9, 7168, v8
    v_lshlrev_b32_e64 v10, 1, v5
    v_mul_u32_u24 v12, 1792, v7
    v_lshl_add_u32 v12, v5, 2, v12
    v_add_u32 v13, 14336, v12
    v_add_u32 v14, 3584, v12
    v_add_u32 v15, 3584, v13
    v_lshlrev_b32_e64 v6, 2, v6
    v_add_u32 v6, 155648, v6
    s_mov_b32 s44, s4
    s_mov_b32 s45, s5
    s_mov_b32 s46, 1835008
    s_mov_b32 s47, 0x20000
    s_mov_b32 s48, s32
    s_mov_b32 s49, s33
    s_mov_b32 s50, 3670016
    s_mov_b32 s51, 0x20000
    buffer_load_ushort v16, v8, s[44:47], 0 offen offset:0
    buffer_load_ushort v17, v8, s[44:47], 0 offen offset:896
    buffer_load_ushort v18, v8, s[44:47], 0 offen offset:1792
    buffer_load_ushort v19, v8, s[44:47], 0 offen offset:2688
    buffer_load_ushort v20, v9, s[44:47], 0 offen offset:0
    buffer_load_ushort v21, v9, s[44:47], 0 offen offset:896
    buffer_load_ushort v22, v9, s[44:47], 0 offen offset:1792
    buffer_load_ushort v23, v9, s[44:47], 0 offen offset:2688
    global_load_ushort v24, v10, s[20:21]
    global_load_ushort v25, v10, s[30:31]
    v_mov_b32 v2, 158240
K1_SPIN9:
    ds_read_b32 v3, v2
    s_waitcnt lgkmcnt(0)
    v_readfirstlane_b32 s42, v3
    s_nop 2
    s_cmp_ge_u32 s42, 7
    s_cbranch_scc0 K1_SPIN9_S
    s_mul_i32 s42, s39, 7
    s_add_u32 s42, s42, s38
    s_lshl_b32 s42, s42, 7
    s_add_u32 s82, s42, 786432
    v_lshlrev_b32 v2, 2, v1
    s_lshl_b32 s42, 1, s38
    s_andn2_b32 s86, 0x7f, s42
K1_RPOLL:
    s_mov_b32 exec_lo, s86
    s_mov_b32 exec_hi, 0
    buffer_load_dword v3, v2, s[68:71], s82 offen sc1
    s_waitcnt vmcnt(0)
    v_cmp_ne_u32 vcc, 1, v3
    s_mov_b64 exec, -1
    s_cbranch_vccnz K1_RPOLLS
    v_mov_b32 v2, 158244
    v_mov_b32 v3, 1
    s_mov_b64 exec, 1
    ds_add_u32 v2, v3
    s_mov_b64 exec, -1
    s_branch K1_RED
K1_OWN:
    v_add_u32_e64 v3, s78, v2
    v_cvt_pk_bf16_f32 v32, v128, v129
    v_cvt_pk_bf16_f32 v33, v130, v131
    v_cvt_pk_bf16_f32 v34, v132, v133
    v_cvt_pk_bf16_f32 v35, v134, v135
    ds_write_b128 v3, v[32:35] offset:0
    v_cvt_pk_bf16_f32 v36, v136, v137
    v_cvt_pk_bf16_f32 v37, v138, v139
    v_cvt_pk_bf16_f32 v38, v140, v141
    v_cvt_pk_bf16_f32 v39, v142, v143
    ds_write_b128 v3, v[36:39] offset:1024
    v_cvt_pk_bf16_f32 v40, v144, v145
    v_cvt_pk_bf16_f32 v41, v146, v147
    v_cvt_pk_bf16_f32 v42, v148, v149
    v_cvt_pk_bf16_f32 v43, v150, v151
    ds_write_b128 v3, v[40:43] offset:2048
    v_cvt_pk_bf16_f32 v44, v152, v153
    v_cvt_pk_bf16_f32 v45, v154, v155
    v_cvt_pk_bf16_f32 v46, v156, v157
    v_cvt_pk_bf16_f32 v47, v158, v159
    ds_write_b128 v3, v[44:47] offset:3072
    v_cvt_pk_bf16_f32 v32, v160, v161
    v_cvt_pk_bf16_f32 v33, v162, v163
    v_cvt_pk_bf16_f32 v34, v164, v165
    v_cvt_pk_bf16_f32 v35, v166, v167
    ds_write_b128 v3, v[32:35] offset:4096
    v_cvt_pk_bf16_f32 v36, v168, v169
    v_cvt_pk_bf16_f32 v37, v170, v171
    v_cvt_pk_bf16_f32 v38, v172, v173
    v_cvt_pk_bf16_f32 v39, v174, v175
    ds_write_b128 v3, v[36:39] offset:5120
    v_cvt_pk_bf16_f32 v40, v176, v177
    v_cvt_pk_bf16_f32 v41, v178, v179
    v_cvt_pk_bf16_f32 v42, v180, v181
    v_cvt_pk_bf16_f32 v43, v182, v183
    ds_write_b128 v3, v[40:43] offset:6144
    v_cvt_pk_bf16_f32 v44, v184, v185
    v_cvt_pk_bf16_f32 v45, v186, v187
    v_cvt_pk_bf16_f32 v46, v188, v189
    v_cvt_pk_bf16_f32 v47, v190, v191
    ds_write_b128 v3, v[44:47] offset:7168
    v_and_b32 v3, 31, v1
    v_lshrrev_b32 v4, 5, v1
    s_lshr_b32 s42, s40, 2
    s_lshl_b32 s42, s42, 5
    s_and_b32 s43, s40, 1
    s_lshl_b32 s43, s43, 4
    s_add_u32 s42, s42, s43
    v_lshl_add_u32 v6, v4, 2, s42
    s_bfe_u32 s42, s40, 0x10001
    s_lshl_b32 s42, s42, 5
    s_lshl_b32 s43, s38, 6
    s_add_u32 s42, s42, s43
    v_add_u32 v5, s42, v3
    s_lshl_b32 s42, s39, 6
    v_add_u32_e64 v7, s42, v6
    v_mul_u32_u24 v8, 896, v7
    v_lshl_add_u32 v8, v5, 1, v8
    v_add_u32 v9, 7168, v8
    v_lshlrev_b32_e64 v10, 1, v5
    v_mul_u32_u24 v12, 1792, v7
    v_lshl_add_u32 v12, v5, 2, v12
    v_add_u32 v13, 14336, v12
    v_add_u32 v14, 3584, v12
    v_add_u32 v15, 3584, v13
    v_lshlrev_b32_e64 v6, 2, v6
    v_add_u32 v6, 155648, v6
    s_mov_b32 s44, s4
    s_mov_b32 s45, s5
    s_mov_b32 s46, 1835008
    s_mov_b32 s47, 0x20000
    s_mov_b32 s48, s32
    s_mov_b32 s49, s33
    s_mov_b32 s50, 3670016
    s_mov_b32 s51, 0x20000
    buffer_load_ushort v16, v8, s[44:47], 0 offen offset:0
    buffer_load_ushort v17, v8, s[44:47], 0 offen offset:896
    buffer_load_ushort v18, v8, s[44:47], 0 offen offset:1792
    buffer_load_ushort v19, v8, s[44:47], 0 offen offset:2688
    buffer_load_ushort v20, v9, s[44:47], 0 offen offset:0
    buffer_load_ushort v21, v9, s[44:47], 0 offen offset:896
    buffer_load_ushort v22, v9, s[44:47], 0 offen offset:1792
    buffer_load_ushort v23, v9, s[44:47], 0 offen offset:2688
    global_load_ushort v24, v10, s[20:21]
    global_load_ushort v25, v10, s[30:31]
    s_waitcnt lgkmcnt(0)
    s_branch K1_SIGD
K1_COLL:
    s_cmp_lg_u32 s38, 7
    s_cbranch_scc1 K1_END
    s_mul_i32 s42, s92, 2
    s_cmp_lg_u32 s42, s39
    s_cbranch_scc1 K1_END
    s_cmp_ge_u32 s92, 7
    s_cbranch_scc1 K1_END
    v_lshrrev_b32 v2, 6, v0
    v_and_b32 v1, 63, v0
    v_readfirstlane_b32 s40, v2
    s_mov_b32 s38, s92
    s_nop 0
    s_load_dwordx4 s[4:7], s[0:1], 8
    s_load_dwordx2 s[18:19], s[0:1], 56
    s_load_dwordx4 s[32:35], s[0:1], 112
    s_load_dwordx2 s[36:37], s[0:1], 128
    s_lshl_b32 s42, s38, 6
    v_add_u32 v2, s42, v1
    v_lshlrev_b32 v2, 1, v2
    s_lshl_b32 s42, s38, 15
    s_lshl_b32 s43, s40, 12
    s_add_u32 s42, s42, s43
    s_add_u32 s42, s42, 524288
    v_lshlrev_b32 v3, 4, v1
    v_add_u32 v3, s42, v3
    v_mov_b32 v8, 0
    v_mov_b32 v9, 0
    v_mov_b32 v10, 0
    v_mov_b32 v11, 0
    s_waitcnt lgkmcnt(0)
    s_mov_b32 s68, s36
    s_mov_b32 s69, s37
    s_mov_b32 s70, 16777216
    s_mov_b32 s71, 0x20000
    s_mov_b32 s72, s34
    s_mov_b32 s73, s35
    s_nop 0
    s_mov_b32 s74, 256
    s_mov_b32 s75, 0x20000
    buffer_store_dwordx4 v[8:11], v3, s[68:71], 0 offen offset:0 sc1
    buffer_store_dwordx4 v[8:11], v3, s[68:71], 0 offen offset:1024 sc1
    buffer_store_dwordx4 v[8:11], v3, s[68:71], 0 offen offset:2048 sc1
    buffer_store_dwordx4 v[8:11], v3, s[68:71], 0 offen offset:3072 sc1
    v_lshlrev_b32 v12, 7, v0
    s_lshl_b32 s42, s38, 2
    s_add_u32 s42, s42, 786432
    v_mov_b32 v13, 2146435072
    v_cmp_gt_u32 vcc, 224, v0
    s_nop 1
    v_cndmask_b32 v12, v13, v12, vcc
    buffer_store_dword v8, v12, s[68:71], s42 offen sc1
    global_load_ushort v104, v2, s[4:5]
    global_load_ushort v105, v2, s[6:7]
    global_load_ushort v106, v2, s[18:19]
    s_waitcnt vmcnt(0)
    s_barrier
    s_cmp_lg_u32 s40, 0
    s_cbranch_scc1 K1_CNR
    s_lshl_b32 s42, s38, 5
    v_mov_b32 v5, s42
    v_mov_b32 v6, 1
    s_mov_b64 exec, 1
    buffer_store_dword v6, v5, s[72:75], 0 offen sc1
    s_mov_b64 exec, -1
K1_CNR:
    v_lshlrev_b32 v107, 16, v104
    v_lshlrev_b32 v108, 16, v105
    v_lshlrev_b32 v106, 16, v106
    v_mul_f32 v106, 0x3fb8aa3b, v106
    v_exp_f32 v106, v106
    s_nop 0
    v_cvt_pk_bf16_f32 v106, v106, v106
    v_lshlrev_b32 v106, 16, v106
    v_mul_f32 v109, v106, v107
    v_mul_f32_e64 v110, v106, v108
    v_mul_f32 v109, 0x3fb8aa3b, v109
    v_mul_f32 v110, 0x3e22f983, v110
    v_exp_f32 v109, v109
    v_rndne_f32 v111, v110
    v_sub_f32 v110, v110, v111
    v_cos_f32 v111, v110
    v_sin_f32 v112, v110
    v_mul_f32 v104, v109, v111
    v_mul_f32 v105, v109, v112
    v_mul_f32 v118, v104, v104
    v_mul_f32 v119, v104, v105
    v_fma_f32 v118, -v105, v105, v118
    v_add_f32 v119, v119, v119
    v_mul_f32 v120, v118, v118
    v_mul_f32_e64 v121, v118, v119
    v_fma_f32 v120, -v119, v119, v120
    v_add_f32 v121, v121, v121
    v_mul_f32 v118, v120, v120
    v_mul_f32_e64 v119, v120, v121
    v_fma_f32 v118, -v121, v121, v118
    v_add_f32 v119, v119, v119
    v_mul_f32 v120, v118, v118
    v_mul_f32_e64 v121, v118, v119
    v_fma_f32 v120, -v119, v119, v120
    v_add_f32 v121, v121, v121
    v_mul_f32 v118, v120, v120
    v_mul_f32_e64 v119, v120, v121
    v_fma_f32 v118, -v121, v121, v118
    v_add_f32 v119, v119, v119
    v_mul_f32 v120, v118, v118
    v_mul_f32_e64 v121, v118, v119
    v_fma_f32 v120, -v119, v119, v120
    v_add_f32 v121, v121, v121
    v_mul_f32 v110, v120, v120
    v_mul_f32_e64 v111, v120, v121
    v_fma_f32 v110, -v121, v121, v110
    v_add_f32 v111, v111, v111
    v_mul_f32 v112, v110, v120
    v_mul_f32_e64 v113, v110, v121
    v_fma_f32 v112, -v111, v121, v112
    v_fmac_f32 v113, v111, v120
    v_mul_f32 v114, v110, v110
    v_mul_f32_e64 v115, v110, v111
    v_fma_f32 v114, -v111, v111, v114
    v_add_f32 v115, v115, v115
    v_lshlrev_b32 v4, 4, v1
    s_lshl_b32 s42, s38, 15
    s_lshl_b32 s43, s40, 12
    s_add_u32 s42, s42, s43
    s_add_u32 s42, s42, 262144
    v_add_u32 v4, s42, v4
    v_lshlrev_b32 v7, 3, v1
    s_lshl_b32 s42, s40, 9
    v_add_u32 v6, s42, v7
K1_CPOLL:
    s_nop 0
    buffer_load_dwordx4 v[16:19], v3, s[68:71], 0 offen offset:0 sc1
    buffer_load_dwordx4 v[20:23], v3, s[68:71], 0 offen offset:1024 sc1
    buffer_load_dwordx4 v[24:27], v3, s[68:71], 0 offen offset:2048 sc1
    buffer_load_dwordx4 v[28:31], v3, s[68:71], 0 offen offset:3072 sc1
    s_waitcnt vmcnt(0)
    v_and_b32 v12, v18, v22
    v_and_b32 v13, v26, v30
    v_and_b32 v12, v12, v13
    v_cmp_ne_u32 vcc, 1, v12
    s_cbranch_vccnz K1_CPOLLS
    v_fma_f32 v32, v120, v16, v20
    v_fma_f32 v33, v120, v17, v21
    v_fma_f32 v32, -v121, v17, v32
    v_fmac_f32_e64 v33, v121, v16
    v_fma_f32 v34, v120, v32, v24
    v_fma_f32 v35, v120, v33, v25
    v_fma_f32 v34, -v121, v33, v34
    v_fmac_f32_e64 v35, v121, v32
    v_fma_f32 v36, v120, v34, v28
    v_fma_f32 v37, v120, v35, v29
    v_fma_f32 v36, -v121, v35, v36
    v_fmac_f32_e64 v37, v121, v34
    ds_write_b64 v6, v[36:37]
    s_waitcnt lgkmcnt(0)
    s_barrier
    ds_read_b64 v[40:41], v7 offset:0
    ds_read_b64 v[42:43], v7 offset:512
    ds_read_b64 v[44:45], v7 offset:1024
    ds_read_b64 v[46:47], v7 offset:1536
    ds_read_b64 v[48:49], v7 offset:2048
    ds_read_b64 v[50:51], v7 offset:2560
    ds_read_b64 v[52:53], v7 offset:3072
    v_mov_b32 v8, 0
    v_mov_b32 v9, 0
    s_waitcnt lgkmcnt(0)
    s_cmp_gt_u32 s40, 0
    s_cbranch_scc0 K1_CH
    s_nop 0
    v_fma_f32 v12, v114, v8, v40
    v_fma_f32 v13, v114, v9, v41
    v_fma_f32 v12, -v115, v9, v12
    v_fmac_f32 v13, v115, v8
    v_mov_b32 v8, v12
    v_mov_b32 v9, v13
    s_cmp_gt_u32 s40, 1
    s_cbranch_scc0 K1_CH
    s_nop 0
    v_fma_f32 v12, v114, v8, v42
    v_fma_f32 v13, v114, v9, v43
    v_fma_f32 v12, -v115, v9, v12
    v_fmac_f32 v13, v115, v8
    v_mov_b32 v8, v12
    v_mov_b32 v9, v13
    s_cmp_gt_u32 s40, 2
    s_cbranch_scc0 K1_CH
    s_nop 0
    v_fma_f32 v12, v114, v8, v44
    v_fma_f32 v13, v114, v9, v45
    v_fma_f32 v12, -v115, v9, v12
    v_fmac_f32 v13, v115, v8
    v_mov_b32 v8, v12
    v_mov_b32 v9, v13
    s_cmp_gt_u32 s40, 3
    s_cbranch_scc0 K1_CH
    s_nop 0
    v_fma_f32 v12, v114, v8, v46
    v_fma_f32 v13, v114, v9, v47
    v_fma_f32 v12, -v115, v9, v12
    v_fmac_f32 v13, v115, v8
    v_mov_b32 v8, v12
    v_mov_b32 v9, v13
    s_cmp_gt_u32 s40, 4
    s_cbranch_scc0 K1_CH
    s_nop 0
    v_fma_f32 v12, v114, v8, v48
    v_fma_f32 v13, v114, v9, v49
    v_fma_f32 v12, -v115, v9, v12
    v_fmac_f32 v13, v115, v8
    v_mov_b32 v8, v12
    v_mov_b32 v9, v13
    s_cmp_gt_u32 s40, 5
    s_cbranch_scc0 K1_CH
    s_nop 0
    v_fma_f32 v12, v114, v8, v50
    v_fma_f32 v13, v114, v9, v51
    v_fma_f32 v12, -v115, v9, v12
    v_fmac_f32 v13, v115, v8
    v_mov_b32 v8, v12
    v_mov_b32 v9, v13
    s_cmp_gt_u32 s40, 6
    s_cbranch_scc0 K1_CH
    s_nop 0
    v_fma_f32 v12, v114, v8, v52
    v_fma_f32 v13, v114, v9, v53
    v_fma_f32 v12, -v115, v9, v12
    v_fmac_f32 v13, v115, v8
    v_mov_b32 v8, v12
    v_mov_b32 v9, v13
K1_CH:
    v_mov_b32 v58, 1
    v_mov_b32 v59, 0
    v_mov_b32 v56, v8
    v_mov_b32_e64 v57, v9
    buffer_store_dwordx4 v[56:59], v4, s[68:71], 0 offen offset:0 sc1
    v_mov_b32 v62, 1
    v_mov_b32 v63, 0
    v_fma_f32 v60, v120, v8, v16
    v_fma_f32 v61, v120, v9, v17
    v_fma_f32 v60, -v121, v9, v60
    v_fmac_f32_e64 v61, v121, v8
    buffer_store_dwordx4 v[60:63], v4, s[68:71], 0 offen offset:1024 sc1
    v_mov_b32 v66, 1
    v_mov_b32 v67, 0
    v_fma_f32 v64, v110, v8, v32
    v_fma_f32 v65, v110, v9, v33
    v_fma_f32 v64, -v111, v9, v64
    v_fmac_f32_e64 v65, v111, v8
    buffer_store_dwordx4 v[64:67], v4, s[68:71], 0 offen offset:2048 sc1
    v_mov_b32 v70, 1
    v_mov_b32 v71, 0
    v_fma_f32 v68, v112, v8, v34
    v_fma_f32 v69, v112, v9, v35
    v_fma_f32 v68, -v113, v9, v68
    v_fmac_f32_e64 v69, v113, v8
    buffer_store_dwordx4 v[68:71], v4, s[68:71], 0 offen offset:3072 sc1
    s_endpgm
K1_SPIN1_S:
    s_sleep 1
    s_branch K1_SPIN1
K1_SPIN2_S:
    s_sleep 1
    s_branch K1_SPIN2
K1_SPIN3_S:
    s_sleep 1
    s_branch K1_SPIN3
K1_SPIN4_S:
    s_sleep 1
    s_branch K1_SPIN4
K1_SPIN5_S:
    s_sleep 1
    s_branch K1_SPIN5
K1_RDYS:
    s_sleep 4
    s_mov_b64 exec, 0x7f
    buffer_load_dword v251, v249, s[72:75], 0 offen sc1
    s_mov_b64 exec, -1
    s_branch K1_RDY1
K1_SPIN6_S:
    s_sleep 1
    s_branch K1_SPIN6
K1_SPIN7_S:
    s_sleep 1
    s_branch K1_SPIN7
K1_SPIN8_S:
    s_sleep 1
    s_branch K1_SPIN8
K1_SPIN9_S:
    s_sleep 1
    s_branch K1_SPIN9
K1_RPOLLS:
    s_sleep 1
    s_branch K1_RPOLL
K1_CPOLLS:
    s_sleep 1
    s_branch K1_CPOLL
K1_END:
    s_endpgm
.section .rodata,"a"
.p2align 6
.amdhsa_kernel parallel_sum__ssm_conv_s5__mixer_channel_mlp__prompt_kernel
  .amdhsa_next_free_vgpr 256
  .amdhsa_next_free_sgpr 102
  .amdhsa_accum_offset 256
  .amdhsa_group_segment_fixed_size 0
  .amdhsa_kernarg_size 136
  .amdhsa_user_sgpr_count 2
  .amdhsa_user_sgpr_kernarg_segment_ptr 1
  .amdhsa_system_sgpr_workgroup_id_x 1
.end_amdhsa_kernel
```
